```python
import torch

def _softmax(x, axis=-1):
    return torch.softmax(x, dim=axis)
def _gelu(x):
    return torch.nn.functional.gelu(x, approximate="tanh")
def _silu(x):
    return torch.nn.functional.silu(x)
def _sigmoid(x):
    return torch.sigmoid(x)
def _layernorm(x, axis=-1, eps=1e-5):
    m = x.mean(dim=axis, keepdim=True)
    v = x.var(dim=axis, keepdim=True, unbiased=False)
    return (x - m) / torch.sqrt(v + eps)
def _scatter_add(tgt, idx, src, axis=0):
    return tgt.clone().index_add_(axis, idx, src)
def _segment_sum(src, seg, n):
    out = torch.zeros((n,) + src.shape[1:], dtype=src.dtype)
    return out.index_add_(0, seg, src)
def _pad(x, pw):
    flat = tuple(v for pair in reversed(pw) for v in pair)
    return torch.nn.functional.pad(x, flat)

kernel_name = 'sequential_preLN__spectral_gfnet__moe_arch_mod__prompt'

def setup_inputs():

    _w = (lambda a: (lambda t: t.to(torch.bfloat16) if t.is_floating_point() else t)(torch.as_tensor(a)))
    def _A_setup():
        B, S, D = 1, 2048, 576
        Df = D // 2 + 1
        return {
            "x": _w((lambda *s: torch.randn(*s, dtype=torch.bfloat16) * 0.05)(B, S, D)),
            "w_r": _w((lambda *s: torch.randn(*s, dtype=torch.bfloat16) * 0.8)(S, Df) * 0.02),
            "w_i": _w((lambda *s: torch.randn(*s, dtype=torch.bfloat16) * 0.8)(S, Df) * 0.02),
        }
    _A_in = _A_setup()

    def _B_setup():
        B, S, D, F, C = 1, 2048, 576, 4608, 8
        return {
            "x": _w((lambda *s: torch.randn(*s, dtype=torch.bfloat16) * 0.05)(B, S, D)),
            "w_r": _w((lambda *s: torch.randn(*s, dtype=torch.bfloat16) * 0.2)(D)),
            "w_gate": _w((lambda *s: torch.randn(*s, dtype=torch.bfloat16) * 0.2)(D, F)),
            "w_up": _w((lambda *s: torch.randn(*s, dtype=torch.bfloat16) * 0.2)(D, F)),
            "w_down": _w((lambda *s: torch.randn(*s, dtype=torch.bfloat16) * 0.2)(F, D)),
        }
    _B_in = _B_setup()

    return {
        "A_x": _A_in["x"],
        "A_w_r": _A_in["w_r"],
        "A_w_i": _A_in["w_i"],
        "B_x": _B_in["x"],
        "B_w_r": _B_in["w_r"],
        "B_w_gate": _B_in["w_gate"],
        "B_w_up": _B_in["w_up"],
        "B_w_down": _B_in["w_down"],
    }

def reference(A_x, A_w_r, A_w_i, B_x, B_w_r, B_w_gate, B_w_up, B_w_down):
    def _A_ref(x, w_r, w_i):
        B, S, D = x.shape
        X = (lambda x, axes=(-2,-1): torch.fft.rfft2(x.float(), dim=axes))(x, axes=(-2, -1))
        W = w_r + 1j * w_i
        X = X * W
        y = (lambda x, s, axes=(-2,-1): torch.fft.irfft2(x, s=s, dim=axes).to(torch.bfloat16))(X, (S, D), axes=(-2, -1))
        return y

    def _B_ref(x, w_r, w_gate, w_up, w_down):
        B, S, D = x.shape
        C = 8
        r = x @ w_r
        idx = torch.argsort(-r, axis=-1)[:, :C]
        idx_e = (lambda x, n, axis: torch.repeat_interleave(x, n, dim=axis))(idx.reshape(B, C, 1), D, axis=2)
        x_sel = (lambda x, i, axis: torch.take_along_dim(x, i, dim=axis))(x, idx_e, axis=1)
        g = _silu(x_sel @ w_gate)
        u = x_sel @ w_up
        y = (g * u) @ w_down
        r_sel = _sigmoid((lambda x, i, axis: torch.take_along_dim(x, i, dim=axis))(r, idx, axis=1))
        y = y * r_sel.reshape(B, C, 1)
        b_off = (torch.arange(B) * S).reshape(B, 1)
        flat_idx = (idx + b_off).reshape(B * C)
        zero = (x * 0.0).reshape(B * S, D)
        upd = _scatter_add(zero, flat_idx, y.reshape(B * C, D), axis=0)
        return x + upd.reshape(B, S, D)

    x = A_x
    h = x + _A_ref(_layernorm(x, axis=-1), A_w_r, A_w_i)
    h2 = h + _B_ref(_layernorm(h, axis=-1), B_w_r, B_w_gate, B_w_up, B_w_down)
    return h2
```

```asm
; @launch kernel=kf_kernel grid=(256,1,1) block=(640,1,1) lds=153728
.amdgcn_target "amdgcn-amd-amdhsa--gfx950"
.text
.globl kf_kernel
.p2align 8
.type kf_kernel,@function
kf_kernel:
    s_cmp_ge_u32 s2, 256
    s_cbranch_scc1 KF_END
    s_load_dwordx4 s[24:27], s[0:1], 0
    s_load_dwordx2 s[28:29], s[0:1], 16
    s_load_dwordx2 s[30:31], s[0:1], 80
    s_memrealtime s[84:85]

    s_lshr_b32 s16, s2, 7
    s_xor_b32 s16, s16, s2
    s_and_b32 s16, s16, 1
    s_xor_b32 s2, s2, s16
    s_lshl_b32 s16, s16, 7
    s_xor_b32 s2, s2, s16

    v_lshrrev_b32 v2, 6, v0
    v_and_b32 v1, 63, v0
    s_bfe_u32 s18, s2, 0x10003
    s_lshr_b32 s16, s2, 7
    v_readfirstlane_b32 s20, v2
    s_xor_b32 s18, s18, s16
    s_and_b32 s17, s2, 127

    s_lshr_b32 s16, s17, 1
    s_xor_b32 s16, s16, s17
    s_and_b32 s16, s16, 1
    s_mul_i32 s16, s16, 3
    s_xor_b32 s17, s17, s16

    s_mov_b32 s100, s17
    s_lshl_b32 s16, s20, 2
    s_mov_b32 s22, 0x76103298
    s_mov_b32 s23, 0x54
    s_lshr_b64 s[22:23], s[22:23], s16
    s_and_b32 s20, s22, 15
    v_lshl_or_b32 v0, s20, 6, v1
    v_mov_b32 v165, 0x25800
    v_mov_b32 v166, 1
    s_cmp_eq_u32 s20, 9
    s_cbranch_scc1 KF_R9

    s_cmp_lg_u32 s20, 2
    s_cbranch_scc1 KF_NPF

    s_getpc_b64 s[48:49]
    s_add_u32 s48, s48, kf_kernel@rel32@lo+4
    s_addc_u32 s49, s49, kf_kernel@rel32@hi+12
    s_mov_b32 s50, CODE_END-kf_kernel
    s_mov_b32 s51, 0x00020000

    s_lshr_b32 s21, s2, 3
    s_and_b32 s21, s21, 15

    s_mul_i32 s21, s21, 3072
    v_lshlrev_b32 v2, 7, v1

    s_mov_b32 exec_lo, 0xffffff
    s_mov_b32 exec_hi, 0x0
    buffer_load_dword v3, v2, s[48:51], s21 offen
    s_mov_b64 exec, -1
KF_NPF:
    s_cmp_lg_u32 s20, 8
    s_cbranch_scc1 KF_E0

    s_mul_i32 s34, s17, 18432

    v_lshl_add_u32 v16, v1, 4, 0
    v_add_u32 v16, 0x0, v16
    v_mov_b32 v2, 0x400
    v_mov_b32 v3, 0x3f0
    v_cmp_gt_u32 vcc, 9, v1
    v_cndmask_b32 v2, v3, v2, vcc
    v_lshl_add_u32 v17, v1, 4, v2
    v_mov_b32 v2, 0x7f0
    v_mov_b32 v3, 0x7e0
    v_cmp_gt_u32 vcc, 18, v1
    v_cndmask_b32 v2, v3, v2, vcc
    v_lshl_add_u32 v18, v1, 4, v2
    v_mov_b32 v2, 0xbe0
    v_mov_b32 v3, 0xbd0
    v_cmp_gt_u32 vcc, 27, v1
    v_cndmask_b32 v2, v3, v2, vcc
    v_lshl_add_u32 v19, v1, 4, v2
    v_mov_b32 v2, 0xfd0
    v_mov_b32 v3, 0xfc0
    v_cmp_gt_u32 vcc, 36, v1
    v_cndmask_b32 v2, v3, v2, vcc
    v_lshl_add_u32 v20, v1, 4, v2
    v_mov_b32 v2, 0x13c0
    v_mov_b32 v3, 0x13b0
    v_cmp_gt_u32 vcc, 45, v1
    v_cndmask_b32 v2, v3, v2, vcc
    v_lshl_add_u32 v21, v1, 4, v2
    v_mov_b32 v2, 0x17b0
    v_mov_b32 v3, 0x17a0
    v_cmp_gt_u32 vcc, 54, v1
    v_cndmask_b32 v2, v3, v2, vcc
    v_lshl_add_u32 v22, v1, 4, v2
    v_mov_b32 v2, 0x1ba0
    v_mov_b32 v3, 0x1b90
    v_cmp_gt_u32 vcc, 63, v1
    v_cndmask_b32 v2, v3, v2, vcc
    v_lshl_add_u32 v23, v1, 4, v2
    v_lshl_add_u32 v24, v1, 4, 0
    v_add_u32 v24, 0x1f90, v24
    v_mov_b32 v2, 0x2390
    v_mov_b32 v3, 0x2380
    v_cmp_gt_u32 vcc, 8, v1
    v_cndmask_b32 v2, v3, v2, vcc
    v_lshl_add_u32 v25, v1, 4, v2
    v_mov_b32 v2, 0x2780
    v_mov_b32 v3, 0x2770
    v_cmp_gt_u32 vcc, 17, v1
    v_cndmask_b32 v2, v3, v2, vcc
    v_lshl_add_u32 v26, v1, 4, v2
    v_mov_b32 v2, 0x2b70
    v_mov_b32 v3, 0x2b60
    v_cmp_gt_u32 vcc, 26, v1
    v_cndmask_b32 v2, v3, v2, vcc
    v_lshl_add_u32 v27, v1, 4, v2
    v_mov_b32 v2, 0x2f60
    v_mov_b32 v3, 0x2f50
    v_cmp_gt_u32 vcc, 35, v1
    v_cndmask_b32 v2, v3, v2, vcc
    v_lshl_add_u32 v28, v1, 4, v2
    v_mov_b32 v2, 0x3350
    v_mov_b32 v3, 0x3340
    v_cmp_gt_u32 vcc, 44, v1
    v_cndmask_b32 v2, v3, v2, vcc
    v_lshl_add_u32 v29, v1, 4, v2
    v_mov_b32 v2, 0x3740
    v_mov_b32 v3, 0x3730
    v_cmp_gt_u32 vcc, 53, v1
    v_cndmask_b32 v2, v3, v2, vcc
    v_lshl_add_u32 v30, v1, 4, v2
    v_mov_b32 v2, 0x3b30
    v_mov_b32 v3, 0x3b20
    v_cmp_gt_u32 vcc, 62, v1
    v_cndmask_b32 v2, v3, v2, vcc
    v_lshl_add_u32 v31, v1, 4, v2
    v_lshl_add_u32 v32, v1, 4, 0
    v_add_u32 v32, 0x3f20, v32
    v_mov_b32 v2, 0x4320
    v_mov_b32 v3, 0x4310
    v_cmp_gt_u32 vcc, 7, v1
    v_cndmask_b32 v2, v3, v2, vcc
    v_lshl_add_u32 v33, v1, 4, v2
    v_mov_b32 v2, 0x4710
    v_mov_b32 v3, 0x4280
    v_cmp_gt_u32 vcc, 16, v1
    v_cndmask_b32 v2, v3, v2, vcc
    v_lshl_add_u32 v34, v1, 4, v2
    s_waitcnt lgkmcnt(0)
    s_mov_b32 s8, s24
    s_mov_b32 s9, s25
    s_mov_b32 s10, 0x240000
    s_mov_b32 s11, 0x00020000
    s_mov_b32 m0, 116544
    buffer_load_dwordx4 v16, s[8:11], s34 offen lds
    s_mov_b32 m0, 117568
    buffer_load_dwordx4 v17, s[8:11], s34 offen lds
    s_mov_b32 m0, 118592
    buffer_load_dwordx4 v18, s[8:11], s34 offen lds
    s_mov_b32 m0, 119616
    buffer_load_dwordx4 v19, s[8:11], s34 offen lds
    s_mov_b32 m0, 120640
    buffer_load_dwordx4 v20, s[8:11], s34 offen lds
    s_mov_b32 m0, 121664
    buffer_load_dwordx4 v21, s[8:11], s34 offen lds
    s_mov_b32 m0, 122688
    buffer_load_dwordx4 v22, s[8:11], s34 offen lds
    s_mov_b32 m0, 123712
    buffer_load_dwordx4 v23, s[8:11], s34 offen lds
    s_mov_b32 m0, 124736
    buffer_load_dwordx4 v24, s[8:11], s34 offen lds
    s_mov_b32 m0, 125760
    buffer_load_dwordx4 v25, s[8:11], s34 offen lds
    s_mov_b32 m0, 126784
    buffer_load_dwordx4 v26, s[8:11], s34 offen lds
    s_mov_b32 m0, 127808
    buffer_load_dwordx4 v27, s[8:11], s34 offen lds
    s_mov_b32 m0, 128832
    buffer_load_dwordx4 v28, s[8:11], s34 offen lds
    s_mov_b32 m0, 129856
    buffer_load_dwordx4 v29, s[8:11], s34 offen lds
    s_mov_b32 m0, 130880
    buffer_load_dwordx4 v30, s[8:11], s34 offen lds
    s_mov_b32 m0, 131904
    buffer_load_dwordx4 v31, s[8:11], s34 offen lds
    s_mov_b32 m0, 132928
    buffer_load_dwordx4 v32, s[8:11], s34 offen lds
    s_mov_b32 m0, 133952
    buffer_load_dwordx4 v33, s[8:11], s34 offen lds
    s_mov_b32 m0, 134976
    buffer_load_dwordx4 v34, s[8:11], s34 offen lds
    s_barrier
    s_setprio 3
KF_E0:
    s_cmp_lg_u32 s20, 0
    s_cbranch_scc1 KF_E2
    v_lshlrev_b32 v2, 2, v1
    v_add_u32 v2, 0x25780, v2
    v_mov_b32 v3, 0
    ds_write_b32 v2, v3

KF_E2:
KF_E1:
    v_and_b32 v7, 15, v1
    s_lshl_b32 s21, s20, 4
    v_add_u32 v7, s21, v7
    v_lshlrev_b32 v7, 1, v7
    v_add_u32 v6, s18, v7
    v_cmp_eq_u32 vcc, 0, v6
    v_mov_b32 v8, 0x120
    v_lshrrev_b32 v9, 4, v1
    v_cndmask_b32 v8, v6, v8, vcc
    v_cvt_f32_u32 v8, v8
    v_mul_u32_u24 v10, 40, v9
    v_cvt_f32_u32 v10, v10
    v_mul_f32 v10, v10, v8
    v_mul_f32 v11, 0xbae38e39, v8

    v_mul_f32 v113, 0x3ae38e39, v10
    v_floor_f32 v113, v113
    v_fmac_f32 v10, 0xc4100000, v113
    v_mul_f32 v112, 0xbae38e39, v10
    v_add_f32 v113, v112, v11
    v_fma_f32 v114, 2.0, v11, v112
    v_add_f32 v115, v114, v11
    v_add_f32 v12, v11, v11
    v_cos_f32 v12, v12

    v_cos_f32 v116, v112
    v_cos_f32 v117, v113
    v_cos_f32 v118, v114
    v_cos_f32 v119, v115
    v_sin_f32 v120, v112
    v_sin_f32 v121, v113
    v_sin_f32 v122, v114
    v_sin_f32 v123, v115
    v_add_f32 v12, v12, v12
    v_cmp_eq_u32 vcc, 3, v9
    v_mov_b32 v14, 0xffff
    v_cndmask_b32 v13, -1, 0, vcc
    v_cndmask_b32 v14, -1, v14, vcc

    v_cvt_pk_bf16_f32 v64, v116, v117
    v_cvt_pk_bf16_f32 v84, v120, v121
    v_pk_fma_f32 v[116:117], v[118:119], v[12:13], v[116:117] op_sel_hi:[1,0,1] neg_lo:[0,0,1] neg_hi:[0,0,1]
    v_cvt_pk_bf16_f32 v65, v118, v119
    v_pk_fma_f32 v[120:121], v[122:123], v[12:13], v[120:121] op_sel_hi:[1,0,1] neg_lo:[0,0,1] neg_hi:[0,0,1]
    v_cvt_pk_bf16_f32 v85, v122, v123
    v_pk_fma_f32 v[118:119], v[116:117], v[12:13], v[118:119] op_sel_hi:[1,0,1] neg_lo:[0,0,1] neg_hi:[0,0,1]
    v_cvt_pk_bf16_f32 v66, v116, v117
    v_pk_fma_f32 v[122:123], v[120:121], v[12:13], v[122:123] op_sel_hi:[1,0,1] neg_lo:[0,0,1] neg_hi:[0,0,1]
    v_cvt_pk_bf16_f32 v86, v120, v121
    v_pk_fma_f32 v[116:117], v[118:119], v[12:13], v[116:117] op_sel_hi:[1,0,1] neg_lo:[0,0,1] neg_hi:[0,0,1]
    v_cvt_pk_bf16_f32 v67, v118, v119
    v_pk_fma_f32 v[120:121], v[122:123], v[12:13], v[120:121] op_sel_hi:[1,0,1] neg_lo:[0,0,1] neg_hi:[0,0,1]
    v_cvt_pk_bf16_f32 v87, v122, v123
    v_pk_fma_f32 v[118:119], v[116:117], v[12:13], v[118:119] op_sel_hi:[1,0,1] neg_lo:[0,0,1] neg_hi:[0,0,1]
    v_cvt_pk_bf16_f32 v68, v116, v117
    v_pk_fma_f32 v[122:123], v[120:121], v[12:13], v[122:123] op_sel_hi:[1,0,1] neg_lo:[0,0,1] neg_hi:[0,0,1]
    v_cvt_pk_bf16_f32 v88, v120, v121
    v_pk_fma_f32 v[116:117], v[118:119], v[12:13], v[116:117] op_sel_hi:[1,0,1] neg_lo:[0,0,1] neg_hi:[0,0,1]
    v_cvt_pk_bf16_f32 v69, v118, v119
    v_pk_fma_f32 v[120:121], v[122:123], v[12:13], v[120:121] op_sel_hi:[1,0,1] neg_lo:[0,0,1] neg_hi:[0,0,1]
    v_cvt_pk_bf16_f32 v89, v122, v123
    s_cmp_eq_u32 s20, 8
    s_cbranch_scc1 A_NBAR
    s_waitcnt lgkmcnt(0)
    s_barrier

A_NBAR:
    v_pk_fma_f32 v[118:119], v[116:117], v[12:13], v[118:119] op_sel_hi:[1,0,1] neg_lo:[0,0,1] neg_hi:[0,0,1]
    v_cvt_pk_bf16_f32 v70, v116, v117
    v_pk_fma_f32 v[122:123], v[120:121], v[12:13], v[122:123] op_sel_hi:[1,0,1] neg_lo:[0,0,1] neg_hi:[0,0,1]
    v_cvt_pk_bf16_f32 v90, v120, v121
    v_pk_fma_f32 v[116:117], v[118:119], v[12:13], v[116:117] op_sel_hi:[1,0,1] neg_lo:[0,0,1] neg_hi:[0,0,1]
    v_cvt_pk_bf16_f32 v71, v118, v119
    v_pk_fma_f32 v[120:121], v[122:123], v[12:13], v[120:121] op_sel_hi:[1,0,1] neg_lo:[0,0,1] neg_hi:[0,0,1]
    v_cvt_pk_bf16_f32 v91, v122, v123
    v_pk_fma_f32 v[118:119], v[116:117], v[12:13], v[118:119] op_sel_hi:[1,0,1] neg_lo:[0,0,1] neg_hi:[0,0,1]
    v_cvt_pk_bf16_f32 v72, v116, v117
    v_pk_fma_f32 v[122:123], v[120:121], v[12:13], v[122:123] op_sel_hi:[1,0,1] neg_lo:[0,0,1] neg_hi:[0,0,1]
    v_cvt_pk_bf16_f32 v92, v120, v121
    v_pk_fma_f32 v[116:117], v[118:119], v[12:13], v[116:117] op_sel_hi:[1,0,1] neg_lo:[0,0,1] neg_hi:[0,0,1]
    v_cvt_pk_bf16_f32 v73, v118, v119
    v_pk_fma_f32 v[120:121], v[122:123], v[12:13], v[120:121] op_sel_hi:[1,0,1] neg_lo:[0,0,1] neg_hi:[0,0,1]
    v_cvt_pk_bf16_f32 v93, v122, v123
    v_pk_fma_f32 v[118:119], v[116:117], v[12:13], v[118:119] op_sel_hi:[1,0,1] neg_lo:[0,0,1] neg_hi:[0,0,1]
    v_cvt_pk_bf16_f32 v74, v116, v117
    v_pk_fma_f32 v[122:123], v[120:121], v[12:13], v[122:123] op_sel_hi:[1,0,1] neg_lo:[0,0,1] neg_hi:[0,0,1]
    v_cvt_pk_bf16_f32 v94, v120, v121
    v_pk_fma_f32 v[116:117], v[118:119], v[12:13], v[116:117] op_sel_hi:[1,0,1] neg_lo:[0,0,1] neg_hi:[0,0,1]
    v_cvt_pk_bf16_f32 v75, v118, v119
    v_pk_fma_f32 v[120:121], v[122:123], v[12:13], v[120:121] op_sel_hi:[1,0,1] neg_lo:[0,0,1] neg_hi:[0,0,1]
    v_cvt_pk_bf16_f32 v95, v122, v123
    v_pk_fma_f32 v[118:119], v[116:117], v[12:13], v[118:119] op_sel_hi:[1,0,1] neg_lo:[0,0,1] neg_hi:[0,0,1]
    v_cvt_pk_bf16_f32 v76, v116, v117
    v_pk_fma_f32 v[122:123], v[120:121], v[12:13], v[122:123] op_sel_hi:[1,0,1] neg_lo:[0,0,1] neg_hi:[0,0,1]
    v_cvt_pk_bf16_f32 v96, v120, v121
    v_pk_fma_f32 v[116:117], v[118:119], v[12:13], v[116:117] op_sel_hi:[1,0,1] neg_lo:[0,0,1] neg_hi:[0,0,1]
    v_cvt_pk_bf16_f32 v77, v118, v119
    v_pk_fma_f32 v[120:121], v[122:123], v[12:13], v[120:121] op_sel_hi:[1,0,1] neg_lo:[0,0,1] neg_hi:[0,0,1]
    v_cvt_pk_bf16_f32 v97, v122, v123
    v_pk_fma_f32 v[118:119], v[116:117], v[12:13], v[118:119] op_sel_hi:[1,0,1] neg_lo:[0,0,1] neg_hi:[0,0,1]
    v_cvt_pk_bf16_f32 v78, v116, v117
    v_pk_fma_f32 v[122:123], v[120:121], v[12:13], v[122:123] op_sel_hi:[1,0,1] neg_lo:[0,0,1] neg_hi:[0,0,1]
    v_cvt_pk_bf16_f32 v98, v120, v121
    v_pk_fma_f32 v[116:117], v[118:119], v[12:13], v[116:117] op_sel_hi:[1,0,1] neg_lo:[0,0,1] neg_hi:[0,0,1]
    v_cvt_pk_bf16_f32 v79, v118, v119
    v_pk_fma_f32 v[120:121], v[122:123], v[12:13], v[120:121] op_sel_hi:[1,0,1] neg_lo:[0,0,1] neg_hi:[0,0,1]
    v_cvt_pk_bf16_f32 v99, v122, v123
    v_pk_fma_f32 v[118:119], v[116:117], v[12:13], v[118:119] op_sel_hi:[1,0,1] neg_lo:[0,0,1] neg_hi:[0,0,1]
    v_cvt_pk_bf16_f32 v80, v116, v117
    v_pk_fma_f32 v[122:123], v[120:121], v[12:13], v[122:123] op_sel_hi:[1,0,1] neg_lo:[0,0,1] neg_hi:[0,0,1]
    v_cvt_pk_bf16_f32 v100, v120, v121
    v_pk_fma_f32 v[116:117], v[118:119], v[12:13], v[116:117] op_sel_hi:[1,0,1] neg_lo:[0,0,1] neg_hi:[0,0,1]
    v_cvt_pk_bf16_f32 v81, v118, v119
    v_pk_fma_f32 v[120:121], v[122:123], v[12:13], v[120:121] op_sel_hi:[1,0,1] neg_lo:[0,0,1] neg_hi:[0,0,1]
    v_cvt_pk_bf16_f32 v101, v122, v123
    v_pk_fma_f32 v[118:119], v[116:117], v[12:13], v[118:119] op_sel_hi:[1,0,1] neg_lo:[0,0,1] neg_hi:[0,0,1]
    v_cvt_pk_bf16_f32 v82, v116, v117
    v_pk_fma_f32 v[122:123], v[120:121], v[12:13], v[122:123] op_sel_hi:[1,0,1] neg_lo:[0,0,1] neg_hi:[0,0,1]
    v_cvt_pk_bf16_f32 v102, v120, v121
    v_cvt_pk_bf16_f32 v83, v118, v119
    v_cvt_pk_bf16_f32 v103, v122, v123
    v_and_b32 v76, v14, v76
    v_and_b32 v77, v13, v77
    v_and_b32 v78, v13, v78
    v_and_b32 v79, v13, v79
    v_and_b32 v80, v13, v80
    v_and_b32 v81, v13, v81
    v_and_b32 v82, v13, v82
    v_and_b32 v83, v13, v83
    v_and_b32 v96, v14, v96
    v_and_b32 v97, v13, v97
    v_and_b32 v98, v13, v98
    v_and_b32 v99, v13, v99
    v_and_b32 v100, v13, v100
    v_and_b32 v101, v13, v101
    v_and_b32 v102, v13, v102
    v_and_b32 v103, v13, v103
    s_setprio 0
    s_cmp_lg_u32 s20, 8
    s_cbranch_scc1 A_N8
    s_waitcnt vmcnt(0)

    s_mov_b64 exec, 1
    ds_add_u32 v165, v166 offset:0
    s_mov_b64 exec, -1
    s_branch A_MM
A_N8:
    s_cmp_eq_u32 s20, 0
    s_cbranch_scc1 A_S4
    s_cmp_lg_u32 s20, 4
    s_cbranch_scc1 A_N4
    s_and_b32 s21, s2, 0xf7
    s_cmp_lg_u32 s21, 160
    s_cbranch_scc1 A_MM
    s_load_dwordx2 s[56:57], s[0:1], 32
    v_lshlrev_b32 v8, 4, v1
    v_mov_b32 v16, 0
    v_mov_b32 v17, 0
    ds_write_b64 v16, v[16:17] offset:2176
    s_mov_b32 m0, 1024
    s_waitcnt lgkmcnt(0)

    s_mov_b32 s56, s56
    s_mov_b32 s57, s57
    s_mov_b32 s58, 0x480
    s_mov_b32 s59, 0x00020000
    buffer_load_dwordx4 v8, s[56:59], 0 offen lds
    s_mov_b64 exec, 0xff
    buffer_load_dwordx4 v8, s[56:59], 0 offen offset:1024 lds
    s_mov_b64 exec, -1
    buffer_load_dwordx4 v[104:107], v8, s[56:59], 0 offen
    buffer_load_dwordx4 v[108:111], v8, s[56:59], 0 offen offset:1024

    v_mov_b32 v7, 0
    v_min_u32 v10, 19, v1

    v_mul_u32_u24 v11, 336, v7
    v_lshl_add_u32 v11, v10, 4, v11
    v_add_u32 v11, 4096, v11
    v_mul_u32_u24 v7, 1168, v7
    v_add_u32 v7, 1024, v7
    v_lshl_add_u32 v8, v10, 4, v7
    v_lshlrev_b32 v2, 4, v10
    v_sub_u32 v15, v7, v2
    s_mov_b32 s36, 0x3f80
    s_mov_b32 s37, 0x3f800000
    s_lshl_b32 s21, s18, 15
    s_or_b32 s38, s36, s21
    s_lshl_b32 s21, s18, 31
    s_or_b32 s39, s37, s21
    v_mov_b32 v34, s36
    v_mov_b32 v35, s38
    v_cmp_eq_u32 vcc, 18, v10
    v_cmp_eq_u32 s[22:23], 0, v10
    s_or_b64 vcc, vcc, s[22:23]
    v_cndmask_b32 v34, v34, 0, vcc
    v_cndmask_b32 v35, v35, 0, vcc

    s_waitcnt vmcnt(0) lgkmcnt(0)
    ds_read_b128 v[16:19], v8
    ds_read_b128 v[20:23], v8 offset:576
    ds_read_b128 v[24:27], v15 offset:1136
    ds_read_b128 v[28:31], v15 offset:560
    ds_read_u16 v32, v15 offset:1152
    ds_read_u16 v33, v15 offset:576
    s_waitcnt lgkmcnt(5)
    v_dot2_f32_bf16 v36, v16, s36, 0
    v_dot2_f32_bf16 v37, v16, s37, 0
    v_dot2_f32_bf16 v38, v17, s36, 0
    v_dot2_f32_bf16 v39, v17, s37, 0
    v_dot2_f32_bf16 v40, v18, s36, 0
    v_dot2_f32_bf16 v41, v18, s37, 0
    v_dot2_f32_bf16 v42, v19, s36, 0
    v_dot2_f32_bf16 v43, v19, s37, 0
    s_waitcnt lgkmcnt(4)
    v_dot2_f32_bf16 v36, v20, s38, v36
    v_dot2_f32_bf16 v37, v20, s39, v37
    v_dot2_f32_bf16 v38, v21, s38, v38
    v_dot2_f32_bf16 v39, v21, s39, v39
    v_dot2_f32_bf16 v40, v22, s38, v40
    v_dot2_f32_bf16 v41, v22, s39, v41
    v_dot2_f32_bf16 v42, v23, s38, v42
    v_dot2_f32_bf16 v43, v23, s39, v43
    s_waitcnt lgkmcnt(3)
    v_dot2_f32_bf16 v45, v27, s37, 0
    v_dot2_f32_bf16 v46, v27, s36, 0
    v_dot2_f32_bf16 v47, v26, s37, 0
    v_dot2_f32_bf16 v48, v26, s36, 0
    v_dot2_f32_bf16 v49, v25, s37, 0
    v_dot2_f32_bf16 v50, v25, s36, 0
    v_dot2_f32_bf16 v51, v24, s37, 0
    s_waitcnt lgkmcnt(0)
    v_dot2_f32_bf16 v44, v32, v34, 0
    v_dot2_f32_bf16 v44, v33, v35, v44
    v_dot2_f32_bf16 v45, v31, s39, v45
    v_dot2_f32_bf16 v46, v31, s38, v46
    v_dot2_f32_bf16 v47, v30, s39, v47
    v_dot2_f32_bf16 v48, v30, s38, v48
    v_dot2_f32_bf16 v49, v29, s39, v49
    v_dot2_f32_bf16 v50, v29, s38, v50
    v_dot2_f32_bf16 v51, v28, s39, v51
    v_pk_add_f32 v[60:61], v[36:37], v[44:45]
    v_pk_add_f32 v[62:63], v[36:37], v[44:45] neg_lo:[0,1] neg_hi:[0,1]
    v_cvt_pk_bf16_f32 v52, v60, v61
    v_cvt_pk_bf16_f32 v56, v62, v63
    v_pk_add_f32 v[60:61], v[38:39], v[46:47]
    v_pk_add_f32 v[62:63], v[38:39], v[46:47] neg_lo:[0,1] neg_hi:[0,1]
    v_cvt_pk_bf16_f32 v53, v60, v61
    v_cvt_pk_bf16_f32 v57, v62, v63
    v_pk_add_f32 v[60:61], v[40:41], v[48:49]
    v_pk_add_f32 v[62:63], v[40:41], v[48:49] neg_lo:[0,1] neg_hi:[0,1]
    v_cvt_pk_bf16_f32 v54, v60, v61
    v_cvt_pk_bf16_f32 v58, v62, v63
    v_pk_add_f32 v[60:61], v[42:43], v[50:51]
    v_pk_add_f32 v[62:63], v[42:43], v[50:51] neg_lo:[0,1] neg_hi:[0,1]
    v_cvt_pk_bf16_f32 v55, v60, v61
    v_cvt_pk_bf16_f32 v59, v62, v63
    ds_write_b128 v11, v[52:55]
    ds_write_b128 v11, v[56:59] offset:5376
    s_waitcnt lgkmcnt(0)
    s_mov_b64 exec, 1
    ds_add_u32 v165, v166 offset:92
    s_mov_b64 exec, -1
    s_mov_b32 s22, 0x3f803f80
    v_dot2_f32_bf16 v112, v104, s22, 0
    s_nop 1
    v_dot2_f32_bf16 v112, v105, s22, v112
    s_nop 1
    v_dot2_f32_bf16 v112, v106, s22, v112
    s_nop 1
    v_dot2_f32_bf16 v112, v107, s22, v112
    s_nop 1
    v_dot2_f32_bf16 v112, v108, s22, v112
    s_nop 1
    v_dot2_f32_bf16 v112, v109, s22, v112
    s_nop 1
    v_dot2_f32_bf16 v112, v110, s22, v112
    s_nop 1
    v_dot2_f32_bf16 v112, v111, s22, v112
    s_nop 1
    s_nop 2
    s_nop 1
    v_add_f32_dpp v113, v112, v112 quad_perm:[1,0,3,2] row_mask:0xf bank_mask:0xf
    s_nop 1
    v_add_f32_dpp v112, v113, v113 quad_perm:[2,3,0,1] row_mask:0xf bank_mask:0xf
    s_nop 1
    v_add_f32_dpp v113, v112, v112 row_half_mirror row_mask:0xf bank_mask:0xf
    s_nop 1
    v_add_f32_dpp v112, v113, v113 row_mirror row_mask:0xf bank_mask:0xf
    v_mov_b32 v113, v112
    s_nop 1
    v_permlane16_swap_b32 v112, v113
    s_nop 0
    v_add_f32 v112, v112, v113
    v_mov_b32 v113, v112
    s_nop 1
    v_permlane32_swap_b32 v112, v113
    s_nop 0
    v_add_f32 v112, v112, v113

    s_branch A_MM
A_S4:

    v_lshrrev_b32 v7, 3, v1
    v_mul_u32_u24 v8, 1168, v7
    v_and_b32 v10, 7, v1
    v_lshl_add_u32 v8, v10, 4, v8
    v_add_u32 v8, 125888, v8
    v_lshlrev_b32 v7, 2, v7
    v_add_u32 v7, 105568, v7
    s_mov_b32 s22, 0x3f803f80

    s_mov_b32 s81, 0
SY1:
    ds_read_b32 v167, v165 offset:0
    s_add_u32 s81, s81, 1
    s_cmp_gt_u32 s81, 0x400000
    s_cbranch_scc1 SY1_D
    s_waitcnt lgkmcnt(0)
    v_readfirstlane_b32 s80, v167
    s_cmp_ge_u32 s80, 1
    s_cbranch_scc0 SY1
SY1_D:
    ds_read_b128 v[16:19], v8 offset:0
    ds_read_b128 v[20:23], v8 offset:128
    ds_read_b128 v[24:27], v8 offset:256
    ds_read_b128 v[28:31], v8 offset:384
    ds_read_b128 v[32:35], v8 offset:512
    ds_read_b128 v[36:39], v8 offset:640
    ds_read_b128 v[40:43], v8 offset:768
    ds_read_b128 v[44:47], v8 offset:896
    ds_read_b128 v[48:51], v8 offset:1024
    s_waitcnt lgkmcnt(8)
    v_dot2_f32_bf16 v52, v16, s22, 0
    v_dot2_f32_bf16 v54, v16, v16, 0
    v_dot2_f32_bf16 v53, v17, s22, 0
    v_dot2_f32_bf16 v55, v17, v17, 0
    v_dot2_f32_bf16 v52, v18, s22, v52
    v_dot2_f32_bf16 v54, v18, v18, v54
    v_dot2_f32_bf16 v53, v19, s22, v53
    v_dot2_f32_bf16 v55, v19, v19, v55
    s_waitcnt lgkmcnt(7)
    v_dot2_f32_bf16 v52, v20, s22, v52
    v_dot2_f32_bf16 v54, v20, v20, v54
    v_dot2_f32_bf16 v53, v21, s22, v53
    v_dot2_f32_bf16 v55, v21, v21, v55
    v_dot2_f32_bf16 v52, v22, s22, v52
    v_dot2_f32_bf16 v54, v22, v22, v54
    v_dot2_f32_bf16 v53, v23, s22, v53
    v_dot2_f32_bf16 v55, v23, v23, v55
    s_waitcnt lgkmcnt(6)
    v_dot2_f32_bf16 v52, v24, s22, v52
    v_dot2_f32_bf16 v54, v24, v24, v54
    v_dot2_f32_bf16 v53, v25, s22, v53
    v_dot2_f32_bf16 v55, v25, v25, v55
    v_dot2_f32_bf16 v52, v26, s22, v52
    v_dot2_f32_bf16 v54, v26, v26, v54
    v_dot2_f32_bf16 v53, v27, s22, v53
    v_dot2_f32_bf16 v55, v27, v27, v55
    s_waitcnt lgkmcnt(5)
    v_dot2_f32_bf16 v52, v28, s22, v52
    v_dot2_f32_bf16 v54, v28, v28, v54
    v_dot2_f32_bf16 v53, v29, s22, v53
    v_dot2_f32_bf16 v55, v29, v29, v55
    v_dot2_f32_bf16 v52, v30, s22, v52
    v_dot2_f32_bf16 v54, v30, v30, v54
    v_dot2_f32_bf16 v53, v31, s22, v53
    v_dot2_f32_bf16 v55, v31, v31, v55
    s_waitcnt lgkmcnt(4)
    v_dot2_f32_bf16 v52, v32, s22, v52
    v_dot2_f32_bf16 v54, v32, v32, v54
    v_dot2_f32_bf16 v53, v33, s22, v53
    v_dot2_f32_bf16 v55, v33, v33, v55
    v_dot2_f32_bf16 v52, v34, s22, v52
    v_dot2_f32_bf16 v54, v34, v34, v54
    v_dot2_f32_bf16 v53, v35, s22, v53
    v_dot2_f32_bf16 v55, v35, v35, v55
    s_waitcnt lgkmcnt(3)
    v_dot2_f32_bf16 v52, v36, s22, v52
    v_dot2_f32_bf16 v54, v36, v36, v54
    v_dot2_f32_bf16 v53, v37, s22, v53
    v_dot2_f32_bf16 v55, v37, v37, v55
    v_dot2_f32_bf16 v52, v38, s22, v52
    v_dot2_f32_bf16 v54, v38, v38, v54
    v_dot2_f32_bf16 v53, v39, s22, v53
    v_dot2_f32_bf16 v55, v39, v39, v55
    s_waitcnt lgkmcnt(2)
    v_dot2_f32_bf16 v52, v40, s22, v52
    v_dot2_f32_bf16 v54, v40, v40, v54
    v_dot2_f32_bf16 v53, v41, s22, v53
    v_dot2_f32_bf16 v55, v41, v41, v55
    v_dot2_f32_bf16 v52, v42, s22, v52
    v_dot2_f32_bf16 v54, v42, v42, v54
    v_dot2_f32_bf16 v53, v43, s22, v53
    v_dot2_f32_bf16 v55, v43, v43, v55
    s_waitcnt lgkmcnt(1)
    v_dot2_f32_bf16 v52, v44, s22, v52
    v_dot2_f32_bf16 v54, v44, v44, v54
    v_dot2_f32_bf16 v53, v45, s22, v53
    v_dot2_f32_bf16 v55, v45, v45, v55
    v_dot2_f32_bf16 v52, v46, s22, v52
    v_dot2_f32_bf16 v54, v46, v46, v54
    v_dot2_f32_bf16 v53, v47, s22, v53
    v_dot2_f32_bf16 v55, v47, v47, v55
    s_waitcnt lgkmcnt(0)
    v_dot2_f32_bf16 v52, v48, s22, v52
    v_dot2_f32_bf16 v54, v48, v48, v54
    v_dot2_f32_bf16 v53, v49, s22, v53
    v_dot2_f32_bf16 v55, v49, v49, v55
    v_dot2_f32_bf16 v52, v50, s22, v52
    v_dot2_f32_bf16 v54, v50, v50, v54
    v_dot2_f32_bf16 v53, v51, s22, v53
    v_dot2_f32_bf16 v55, v51, v51, v55
    s_nop 2
    v_add_f32 v52, v52, v53
    v_add_f32 v54, v54, v55

    s_nop 1
    v_add_f32_dpp v53, v52, v52 quad_perm:[1,0,3,2] row_mask:0xf bank_mask:0xf
    v_add_f32_dpp v55, v54, v54 quad_perm:[1,0,3,2] row_mask:0xf bank_mask:0xf
    s_nop 0
    v_add_f32_dpp v52, v53, v53 quad_perm:[2,3,0,1] row_mask:0xf bank_mask:0xf
    v_add_f32_dpp v54, v55, v55 quad_perm:[2,3,0,1] row_mask:0xf bank_mask:0xf
    s_nop 0
    v_add_f32_dpp v53, v52, v52 row_half_mirror row_mask:0xf bank_mask:0xf
    v_add_f32_dpp v55, v54, v54 row_half_mirror row_mask:0xf bank_mask:0xf
    v_mul_f32 v52, 0x3ae38e39, v53
    v_mul_f32 v54, 0x3ae38e39, v55
    v_fma_f32 v54, -v52, v52, v54
    v_add_f32 v55, v54, v54

    v_cvt_pk_bf16_f32 v54, v54, v54
    v_lshlrev_b32 v54, 16, v54
    v_add_f32 v54, 0x3727c5ac, v54
    v_cvt_pk_bf16_f32 v54, v54, v54
    v_lshlrev_b32 v54, 16, v54
    v_sqrt_f32 v54, v54
    s_nop 0
    v_cvt_pk_bf16_f32 v54, v54, v54
    v_lshlrev_b32 v54, 16, v54
    v_rcp_f32 v53, v54
    s_nop 0
    ds_write_b32 v7, v53
    s_waitcnt lgkmcnt(0)
    s_mov_b64 exec, 1
    ds_add_u32 v165, v166 offset:96
    s_mov_b64 exec, -1
    v_cvt_pk_bf16_f32 v56, v52, v52
    v_lshlrev_b32 v56, 16, v56
    v_sub_f32 v57, v52, v56
    v_mul_f32 v54, 0x3be38e39, v54
    v_lshrrev_b32 v7, 3, v1
    v_mul_u32_u24 v8, 80, v7
    v_lshlrev_b32 v10, 2, v7
    v_lshlrev_b32 v7, 4, v7
    ds_write_b32 v8, v55 offset:39944
    ds_write_b64 v7, v[56:57] offset:40640
    ds_write_b32 v10, v54 offset:42080

    s_waitcnt lgkmcnt(0)
    s_mov_b64 exec, 1
    ds_add_u32 v165, v166 offset:124
    s_mov_b64 exec, -1
    s_branch A_MM
A_N4:

    s_cmp_eq_u32 s20, 7
    s_cbranch_scc1 A_ST

    s_sub_u32 s21, s20, 1
    s_cmp_ge_u32 s20, 5
    s_cselect_b32 s22, 1, 0
    s_sub_u32 s21, s21, s22

    v_lshl_or_b32 v2, s21, 6, v1
    v_mul_u32_u24 v7, 3277, v2
    v_lshrrev_b32 v7, 16, v7
    v_mul_u32_u24 v10, 20, v7
    v_sub_u32 v10, v2, v10

    v_mul_u32_u24 v11, 336, v7
    v_lshl_add_u32 v11, v10, 4, v11
    v_add_u32 v11, 105792, v11
    v_mul_u32_u24 v7, 1168, v7
    v_add_u32 v7, 116544, v7
    v_lshl_add_u32 v8, v10, 4, v7
    v_lshlrev_b32 v2, 4, v10
    v_sub_u32 v15, v7, v2
    s_mov_b32 s36, 0x3f80
    s_mov_b32 s37, 0x3f800000
    s_lshl_b32 s21, s18, 15
    s_or_b32 s38, s36, s21
    s_lshl_b32 s21, s18, 31
    s_or_b32 s39, s37, s21
    v_mov_b32 v34, s36
    v_mov_b32 v35, s38
    v_cmp_eq_u32 vcc, 18, v10
    v_cmp_eq_u32 s[22:23], 0, v10
    s_or_b64 vcc, vcc, s[22:23]
    v_cndmask_b32 v34, v34, 0, vcc
    v_cndmask_b32 v35, v35, 0, vcc

    s_mov_b32 s81, 0
SY2:
    ds_read_b32 v167, v165 offset:0
    s_add_u32 s81, s81, 1
    s_cmp_gt_u32 s81, 0x400000
    s_cbranch_scc1 SY2_D
    s_waitcnt lgkmcnt(0)
    v_readfirstlane_b32 s80, v167
    s_cmp_ge_u32 s80, 1
    s_cbranch_scc0 SY2
SY2_D:
    ds_read_b128 v[16:19], v8
    ds_read_b128 v[20:23], v8 offset:576
    ds_read_b128 v[24:27], v15 offset:1136
    ds_read_b128 v[28:31], v15 offset:560
    ds_read_u16 v32, v15 offset:1152
    ds_read_u16 v33, v15 offset:576
    s_waitcnt lgkmcnt(5)
    v_dot2_f32_bf16 v36, v16, s36, 0
    v_dot2_f32_bf16 v37, v16, s37, 0
    v_dot2_f32_bf16 v38, v17, s36, 0
    v_dot2_f32_bf16 v39, v17, s37, 0
    v_dot2_f32_bf16 v40, v18, s36, 0
    v_dot2_f32_bf16 v41, v18, s37, 0
    v_dot2_f32_bf16 v42, v19, s36, 0
    v_dot2_f32_bf16 v43, v19, s37, 0
    s_waitcnt lgkmcnt(4)
    v_dot2_f32_bf16 v36, v20, s38, v36
    v_dot2_f32_bf16 v37, v20, s39, v37
    v_dot2_f32_bf16 v38, v21, s38, v38
    v_dot2_f32_bf16 v39, v21, s39, v39
    v_dot2_f32_bf16 v40, v22, s38, v40
    v_dot2_f32_bf16 v41, v22, s39, v41
    v_dot2_f32_bf16 v42, v23, s38, v42
    v_dot2_f32_bf16 v43, v23, s39, v43
    s_waitcnt lgkmcnt(3)
    v_dot2_f32_bf16 v45, v27, s37, 0
    v_dot2_f32_bf16 v46, v27, s36, 0
    v_dot2_f32_bf16 v47, v26, s37, 0
    v_dot2_f32_bf16 v48, v26, s36, 0
    v_dot2_f32_bf16 v49, v25, s37, 0
    v_dot2_f32_bf16 v50, v25, s36, 0
    v_dot2_f32_bf16 v51, v24, s37, 0
    s_waitcnt lgkmcnt(0)
    v_dot2_f32_bf16 v44, v32, v34, 0
    v_dot2_f32_bf16 v44, v33, v35, v44
    v_dot2_f32_bf16 v45, v31, s39, v45
    v_dot2_f32_bf16 v46, v31, s38, v46
    v_dot2_f32_bf16 v47, v30, s39, v47
    v_dot2_f32_bf16 v48, v30, s38, v48
    v_dot2_f32_bf16 v49, v29, s39, v49
    v_dot2_f32_bf16 v50, v29, s38, v50
    v_dot2_f32_bf16 v51, v28, s39, v51
    v_pk_add_f32 v[60:61], v[36:37], v[44:45]
    v_pk_add_f32 v[62:63], v[36:37], v[44:45] neg_lo:[0,1] neg_hi:[0,1]
    v_cvt_pk_bf16_f32 v52, v60, v61
    v_cvt_pk_bf16_f32 v56, v62, v63
    v_pk_add_f32 v[60:61], v[38:39], v[46:47]
    v_pk_add_f32 v[62:63], v[38:39], v[46:47] neg_lo:[0,1] neg_hi:[0,1]
    v_cvt_pk_bf16_f32 v53, v60, v61
    v_cvt_pk_bf16_f32 v57, v62, v63
    v_pk_add_f32 v[60:61], v[40:41], v[48:49]
    v_pk_add_f32 v[62:63], v[40:41], v[48:49] neg_lo:[0,1] neg_hi:[0,1]
    v_cvt_pk_bf16_f32 v54, v60, v61
    v_cvt_pk_bf16_f32 v58, v62, v63
    v_pk_add_f32 v[60:61], v[42:43], v[50:51]
    v_pk_add_f32 v[62:63], v[42:43], v[50:51] neg_lo:[0,1] neg_hi:[0,1]
    v_cvt_pk_bf16_f32 v55, v60, v61
    v_cvt_pk_bf16_f32 v59, v62, v63
    ds_write_b128 v11, v[52:55]
    ds_write_b128 v11, v[56:59] offset:5376
    s_waitcnt lgkmcnt(0)
    s_mov_b64 exec, 1
    ds_add_u32 v165, v166 offset:4
    s_mov_b64 exec, -1
    s_branch A_MM
A_ST:
    v_lshrrev_b32 v7, 3, v1
    v_mul_u32_u24 v8, 1168, v7
    v_and_b32 v10, 7, v1
    v_lshl_add_u32 v8, v10, 4, v8
    v_add_u32 v8, 116544, v8
    v_lshlrev_b32 v7, 2, v7
    v_add_u32 v7, 105536, v7
    s_mov_b32 s22, 0x3f803f80

    s_mov_b32 s81, 0
SY3:
    ds_read_b32 v167, v165 offset:0
    s_add_u32 s81, s81, 1
    s_cmp_gt_u32 s81, 0x400000
    s_cbranch_scc1 SY3_D
    s_waitcnt lgkmcnt(0)
    v_readfirstlane_b32 s80, v167
    s_cmp_ge_u32 s80, 1
    s_cbranch_scc0 SY3
SY3_D:
    ds_read_b128 v[16:19], v8 offset:0
    ds_read_b128 v[20:23], v8 offset:128
    ds_read_b128 v[24:27], v8 offset:256
    ds_read_b128 v[28:31], v8 offset:384
    ds_read_b128 v[32:35], v8 offset:512
    ds_read_b128 v[36:39], v8 offset:640
    ds_read_b128 v[40:43], v8 offset:768
    ds_read_b128 v[44:47], v8 offset:896
    ds_read_b128 v[48:51], v8 offset:1024
    s_waitcnt lgkmcnt(8)
    v_dot2_f32_bf16 v52, v16, s22, 0
    v_dot2_f32_bf16 v54, v16, v16, 0
    v_dot2_f32_bf16 v53, v17, s22, 0
    v_dot2_f32_bf16 v55, v17, v17, 0
    v_dot2_f32_bf16 v52, v18, s22, v52
    v_dot2_f32_bf16 v54, v18, v18, v54
    v_dot2_f32_bf16 v53, v19, s22, v53
    v_dot2_f32_bf16 v55, v19, v19, v55
    s_waitcnt lgkmcnt(7)
    v_dot2_f32_bf16 v52, v20, s22, v52
    v_dot2_f32_bf16 v54, v20, v20, v54
    v_dot2_f32_bf16 v53, v21, s22, v53
    v_dot2_f32_bf16 v55, v21, v21, v55
    v_dot2_f32_bf16 v52, v22, s22, v52
    v_dot2_f32_bf16 v54, v22, v22, v54
    v_dot2_f32_bf16 v53, v23, s22, v53
    v_dot2_f32_bf16 v55, v23, v23, v55
    s_waitcnt lgkmcnt(6)
    v_dot2_f32_bf16 v52, v24, s22, v52
    v_dot2_f32_bf16 v54, v24, v24, v54
    v_dot2_f32_bf16 v53, v25, s22, v53
    v_dot2_f32_bf16 v55, v25, v25, v55
    v_dot2_f32_bf16 v52, v26, s22, v52
    v_dot2_f32_bf16 v54, v26, v26, v54
    v_dot2_f32_bf16 v53, v27, s22, v53
    v_dot2_f32_bf16 v55, v27, v27, v55
    s_waitcnt lgkmcnt(5)
    v_dot2_f32_bf16 v52, v28, s22, v52
    v_dot2_f32_bf16 v54, v28, v28, v54
    v_dot2_f32_bf16 v53, v29, s22, v53
    v_dot2_f32_bf16 v55, v29, v29, v55
    v_dot2_f32_bf16 v52, v30, s22, v52
    v_dot2_f32_bf16 v54, v30, v30, v54
    v_dot2_f32_bf16 v53, v31, s22, v53
    v_dot2_f32_bf16 v55, v31, v31, v55
    s_waitcnt lgkmcnt(4)
    v_dot2_f32_bf16 v52, v32, s22, v52
    v_dot2_f32_bf16 v54, v32, v32, v54
    v_dot2_f32_bf16 v53, v33, s22, v53
    v_dot2_f32_bf16 v55, v33, v33, v55
    v_dot2_f32_bf16 v52, v34, s22, v52
    v_dot2_f32_bf16 v54, v34, v34, v54
    v_dot2_f32_bf16 v53, v35, s22, v53
    v_dot2_f32_bf16 v55, v35, v35, v55
    s_waitcnt lgkmcnt(3)
    v_dot2_f32_bf16 v52, v36, s22, v52
    v_dot2_f32_bf16 v54, v36, v36, v54
    v_dot2_f32_bf16 v53, v37, s22, v53
    v_dot2_f32_bf16 v55, v37, v37, v55
    v_dot2_f32_bf16 v52, v38, s22, v52
    v_dot2_f32_bf16 v54, v38, v38, v54
    v_dot2_f32_bf16 v53, v39, s22, v53
    v_dot2_f32_bf16 v55, v39, v39, v55
    s_waitcnt lgkmcnt(2)
    v_dot2_f32_bf16 v52, v40, s22, v52
    v_dot2_f32_bf16 v54, v40, v40, v54
    v_dot2_f32_bf16 v53, v41, s22, v53
    v_dot2_f32_bf16 v55, v41, v41, v55
    v_dot2_f32_bf16 v52, v42, s22, v52
    v_dot2_f32_bf16 v54, v42, v42, v54
    v_dot2_f32_bf16 v53, v43, s22, v53
    v_dot2_f32_bf16 v55, v43, v43, v55
    s_waitcnt lgkmcnt(1)
    v_dot2_f32_bf16 v52, v44, s22, v52
    v_dot2_f32_bf16 v54, v44, v44, v54
    v_dot2_f32_bf16 v53, v45, s22, v53
    v_dot2_f32_bf16 v55, v45, v45, v55
    v_dot2_f32_bf16 v52, v46, s22, v52
    v_dot2_f32_bf16 v54, v46, v46, v54
    v_dot2_f32_bf16 v53, v47, s22, v53
    v_dot2_f32_bf16 v55, v47, v47, v55
    s_waitcnt lgkmcnt(0)
    v_dot2_f32_bf16 v52, v48, s22, v52
    v_dot2_f32_bf16 v54, v48, v48, v54
    v_dot2_f32_bf16 v53, v49, s22, v53
    v_dot2_f32_bf16 v55, v49, v49, v55
    v_dot2_f32_bf16 v52, v50, s22, v52
    v_dot2_f32_bf16 v54, v50, v50, v54
    v_dot2_f32_bf16 v53, v51, s22, v53
    v_dot2_f32_bf16 v55, v51, v51, v55
    s_nop 2
    v_add_f32 v52, v52, v53
    v_add_f32 v54, v54, v55

    s_nop 1
    v_add_f32_dpp v53, v52, v52 quad_perm:[1,0,3,2] row_mask:0xf bank_mask:0xf
    v_add_f32_dpp v55, v54, v54 quad_perm:[1,0,3,2] row_mask:0xf bank_mask:0xf
    s_nop 0
    v_add_f32_dpp v52, v53, v53 quad_perm:[2,3,0,1] row_mask:0xf bank_mask:0xf
    v_add_f32_dpp v54, v55, v55 quad_perm:[2,3,0,1] row_mask:0xf bank_mask:0xf
    s_nop 0
    v_add_f32_dpp v53, v52, v52 row_half_mirror row_mask:0xf bank_mask:0xf
    v_add_f32_dpp v55, v54, v54 row_half_mirror row_mask:0xf bank_mask:0xf
    v_mul_f32 v52, 0x3ae38e39, v53
    v_mul_f32 v54, 0x3ae38e39, v55
    v_fma_f32 v54, -v52, v52, v54
    v_add_f32 v55, v54, v54

    v_cvt_pk_bf16_f32 v54, v54, v54
    v_lshlrev_b32 v54, 16, v54
    v_add_f32 v54, 0x3727c5ac, v54
    v_cvt_pk_bf16_f32 v54, v54, v54
    v_lshlrev_b32 v54, 16, v54
    v_sqrt_f32 v54, v54
    s_nop 0
    v_cvt_pk_bf16_f32 v54, v54, v54
    v_lshlrev_b32 v54, 16, v54
    v_rcp_f32 v53, v54
    s_nop 0
    ds_write_b32 v7, v53
    s_waitcnt lgkmcnt(0)
    s_mov_b64 exec, 1
    ds_add_u32 v165, v166 offset:96
    s_mov_b64 exec, -1
    v_cvt_pk_bf16_f32 v56, v52, v52
    v_lshlrev_b32 v56, 16, v56
    v_sub_f32 v57, v52, v56
    v_mul_f32 v54, 0x3be38e39, v54
    v_lshrrev_b32 v7, 3, v1
    v_mul_u32_u24 v8, 80, v7
    v_lshlrev_b32 v10, 2, v7
    v_lshlrev_b32 v7, 4, v7
    ds_write_b32 v8, v55 offset:39304
    ds_write_b64 v7, v[56:57] offset:40512
    ds_write_b32 v10, v54 offset:42048

    s_waitcnt lgkmcnt(0)
    s_mov_b64 exec, 1
    ds_add_u32 v165, v166 offset:124
    s_mov_b64 exec, -1
A_MM:
    v_and_b32 v7, 15, v1
    v_mul_u32_u24 v8, 336, v7
    v_mul_u32_u24 v10, 80, v9
    v_add_u32 v8, v8, v10
    v_add_u32 v8, 105792, v8
    v_lshlrev_b32 v10, 4, v9
    v_mov_b32 v5, v6

    v_lshl_add_u32 v6, v6, 13, v10
    s_and_b32 s21, s17, 1
    s_lshl_b32 s21, s21, 12

    v_add_u32 v10, 105536, v10
    s_lshr_b32 s22, s17, 1
    s_lshl_b32 s22, s22, 6
    s_add_u32 s21, s21, s22

    s_mov_b32 s81, 0
SY4:
    ds_read_b32 v167, v165 offset:4
    s_add_u32 s81, s81, 1
    s_cmp_gt_u32 s81, 0x400000
    s_cbranch_scc1 SY4_D
    s_waitcnt lgkmcnt(0)
    v_readfirstlane_b32 s80, v167
    s_cmp_ge_u32 s80, 5
    s_cbranch_scc0 SY4
SY4_D:
    ds_read_b128 v[16:19], v8 offset:0
    ds_read_b128 v[36:39], v8 offset:5376
    ds_read_b128 v[20:23], v8 offset:16
    ds_read_b128 v[40:43], v8 offset:5392
    ds_read_b128 v[24:27], v8 offset:32
    ds_read_b128 v[44:47], v8 offset:5408
    ds_read_b128 v[28:31], v8 offset:48
    ds_read_b128 v[48:51], v8 offset:5424
    ds_read_b128 v[32:35], v8 offset:64
    ds_read_b128 v[52:55], v8 offset:5440
    s_mov_b32 s12, s30
    s_mov_b32 s13, s31
    s_mov_b32 s14, 0x240000
    s_mov_b32 s15, 0x00020000
    s_waitcnt lgkmcnt(8)
    v_mfma_f32_16x16x32_bf16 v[56:59], v[16:19], v[64:67], 0
    v_mfma_f32_16x16x32_bf16 v[60:63], v[36:39], v[84:87], 0
    s_waitcnt lgkmcnt(6)
    v_mfma_f32_16x16x32_bf16 v[56:59], v[20:23], v[68:71], v[56:59]
    v_mfma_f32_16x16x32_bf16 v[60:63], v[40:43], v[88:91], v[60:63]
    s_waitcnt lgkmcnt(4)
    v_mfma_f32_16x16x32_bf16 v[56:59], v[24:27], v[72:75], v[56:59]
    v_mfma_f32_16x16x32_bf16 v[60:63], v[44:47], v[92:95], v[60:63]
    s_waitcnt lgkmcnt(2)
    v_mfma_f32_16x16x32_bf16 v[56:59], v[28:31], v[76:79], v[56:59]
    v_mfma_f32_16x16x32_bf16 v[60:63], v[48:51], v[96:99], v[60:63]
    s_waitcnt lgkmcnt(0)
    v_mfma_f32_16x16x32_bf16 v[56:59], v[32:35], v[80:83], v[56:59]
    v_mfma_f32_16x16x32_bf16 v[60:63], v[52:55], v[100:103], v[60:63]
    s_mov_b32 s81, 0
SY5:
    ds_read_b32 v167, v165 offset:96
    s_add_u32 s81, s81, 1
    s_cmp_gt_u32 s81, 0x400000
    s_cbranch_scc1 SY5_D
    s_waitcnt lgkmcnt(0)
    v_readfirstlane_b32 s80, v167
    s_cmp_ge_u32 s80, 2
    s_cbranch_scc0 SY5
SY5_D:
    ds_read_b128 v[16:19], v10
    s_waitcnt lgkmcnt(0)
    v_pk_mul_f32 v[20:21], v[56:57], v[16:17]
    v_pk_mul_f32 v[22:23], v[58:59], v[18:19]
    v_pk_mul_f32 v[24:25], v[60:61], v[16:17]
    v_pk_mul_f32 v[26:27], v[62:63], v[18:19]
    v_cvt_pk_bf16_f32 v28, v20, v21
    v_cvt_pk_bf16_f32 v29, v22, v23
    v_cvt_pk_bf16_f32 v30, v24, v25
    v_cvt_pk_bf16_f32 v31, v26, v27
    v_or_b32 v28, 1, v28

    s_mov_b32 s81, 0
SY6:
    ds_read_b32 v167, v165 offset:12
    s_add_u32 s81, s81, 1
    s_cmp_gt_u32 s81, 0x400000
    s_cbranch_scc1 SY6_D
    s_waitcnt lgkmcnt(0)
    v_readfirstlane_b32 s80, v167
    s_cmp_ge_u32 s80, 1
    s_cbranch_scc0 SY6
SY6_D:
    buffer_store_dwordx4 v[28:31], v6, s[12:15], s21 offen sc0 sc1
    s_mov_b64 exec, 1
    ds_add_u32 v165, v166 offset:40
    s_mov_b64 exec, -1
    s_and_b32 s21, s2, 0xf7
    s_cmp_lg_u32 s21, 160
    s_cbranch_scc1 A_NXF
    v_mul_u32_u24 v8, 80, v9

    s_mov_b32 s81, 0
SY7:
    ds_read_b32 v167, v165 offset:92
    s_add_u32 s81, s81, 1
    s_cmp_gt_u32 s81, 0x400000
    s_cbranch_scc1 SY7_D
    s_waitcnt lgkmcnt(0)
    v_readfirstlane_b32 s80, v167
    s_cmp_ge_u32 s80, 1
    s_cbranch_scc1 SY7_D
    s_sleep 1
    s_branch SY7
SY7_D:
    ds_read_b128 v[16:19], v8 offset:4096
    ds_read_b128 v[36:39], v8 offset:9472
    ds_read_b128 v[20:23], v8 offset:4112
    ds_read_b128 v[40:43], v8 offset:9488
    ds_read_b128 v[24:27], v8 offset:4128
    ds_read_b128 v[44:47], v8 offset:9504
    ds_read_b128 v[28:31], v8 offset:4144
    ds_read_b128 v[48:51], v8 offset:9520
    ds_read_b128 v[32:35], v8 offset:4160
    ds_read_b128 v[52:55], v8 offset:9536
    s_add_u32 s12, s30, 0x1428000
    s_addc_u32 s13, s31, 0
    s_mov_b32 s14, 0x2000
    s_mov_b32 s15, 0x00020000
    s_waitcnt lgkmcnt(8)
    v_mfma_f32_16x16x32_bf16 v[56:59], v[16:19], v[64:67], 0
    v_mfma_f32_16x16x32_bf16 v[60:63], v[36:39], v[84:87], 0
    s_waitcnt lgkmcnt(6)
    v_mfma_f32_16x16x32_bf16 v[56:59], v[20:23], v[68:71], v[56:59]
    v_mfma_f32_16x16x32_bf16 v[60:63], v[40:43], v[88:91], v[60:63]
    s_waitcnt lgkmcnt(4)
    v_mfma_f32_16x16x32_bf16 v[56:59], v[24:27], v[72:75], v[56:59]
    v_mfma_f32_16x16x32_bf16 v[60:63], v[44:47], v[92:95], v[60:63]
    s_waitcnt lgkmcnt(2)
    v_mfma_f32_16x16x32_bf16 v[56:59], v[28:31], v[76:79], v[56:59]
    v_mfma_f32_16x16x32_bf16 v[60:63], v[48:51], v[96:99], v[60:63]
    s_waitcnt lgkmcnt(0)
    v_mfma_f32_16x16x32_bf16 v[56:59], v[32:35], v[80:83], v[56:59]
    v_mfma_f32_16x16x32_bf16 v[60:63], v[52:55], v[100:103], v[60:63]
    s_mov_b32 s81, 0
SY8:
    ds_read_b32 v167, v165 offset:8
    s_add_u32 s81, s81, 1
    s_cmp_gt_u32 s81, 0x400000
    s_cbranch_scc1 SY8_D
    s_waitcnt lgkmcnt(0)
    v_readfirstlane_b32 s80, v167
    s_cmp_ge_u32 s80, 1
    s_cbranch_scc1 SY8_D
    s_sleep 1
    s_branch SY8
SY8_D:
    v_and_b32 v4, 3, v5
    v_mov_b32 v8, 0x80000000
    v_cmp_eq_u32 vcc, 3, v4
    v_cndmask_b32 v8, 0, v8, vcc
    v_cvt_pk_bf16_f32 v20, v56, v60
    v_xor_b32 v20, v8, v20
    v_lshrrev_b32 v5, 1, v5
    v_lshlrev_b32 v5, 2, v5
    v_lshl_add_u32 v5, v9, 10, v5
    s_lshl_b32 s21, s18, 12
    buffer_store_dword v20, v5, s[12:15], s21 offen sc0 sc1
    s_cmp_lg_u32 s20, 4
    s_cbranch_scc1 A_NXF
    v_lshlrev_b32 v5, 10, v9
    buffer_store_dword v112, v5, s[12:15], s21 offen offset:576 sc0 sc1
A_NXF:

    s_cmp_lt_u32 s20, 5
    s_cbranch_scc1 KF_DISP

    s_lshr_b32 s16, s2, 4
    s_lshl_b32 s16, s16, 3
    s_and_b32 s17, s2, 7
    s_add_u32 s16, s16, s17
    s_lshr_b32 s17, s16, 1
    s_and_b32 s19, s16, 1
    s_mul_i32 s36, s17, 578
    s_and_b32 s37, s36, 15
    v_subrev_u32 v2, 320, v0
    v_and_b32 v3, 3, v2
    v_lshrrev_b32 v2, 2, v2
    v_mul_u32_u24 v6, 2624, v3
    v_lshl_add_u32 v6, v2, 2, v6
    s_lshl_b32 s21, s18, 1
    s_add_u32 s21, s21, s37
    s_add_u32 s21, s21, 84544
    v_add_u32 v6, s21, v6
    v_or_b32 v8, s18, v2
    v_cmp_eq_u32 vcc, 0, v8
    v_add_u32 v8, 576, v6
    v_cndmask_b32 v8, v6, v8, vcc

    v_lshlrev_b32 v9, 14, v2
    v_lshl_add_u32 v9, v3, 4, v9

    s_lshl_b32 s21, s17, 7
    s_lshl_b32 s22, s19, 6
    s_add_u32 s21, s21, s22
    s_lshl_b32 s22, s18, 13
    s_add_u32 s21, s21, s22
    s_add_u32 s22, s21, 1048576
    s_add_u32 s23, s22, 1048576

    s_add_u32 s12, s30, 0x400000
    s_addc_u32 s13, s31, 0
    s_mov_b32 s14, 0x240000
    s_mov_b32 s15, 0x00020000
    s_mov_b32 s81, 0
SY9:
    ds_read_b32 v167, v165 offset:8
    s_add_u32 s81, s81, 1
    s_cmp_gt_u32 s81, 0x400000
    s_cbranch_scc1 SY9_D
    s_waitcnt lgkmcnt(0)
    v_readfirstlane_b32 s80, v167
    s_cmp_ge_u32 s80, 1
    s_cbranch_scc1 SY9_D
    s_sleep 1
    s_branch SY9
SY9_D:
    ds_read_u16 v16, v8 offset:0
    ds_read_u16 v17, v8 offset:656
    ds_read_u16 v18, v8 offset:1312
    ds_read_u16 v19, v8 offset:1968
    ds_read_u16 v20, v6 offset:256
    ds_read_u16 v21, v6 offset:912
    ds_read_u16 v22, v6 offset:1568
    ds_read_u16 v23, v6 offset:2224
    ds_read_u16 v24, v6 offset:512
    ds_read_u16 v25, v6 offset:1168
    ds_read_u16 v26, v6 offset:1824
    ds_read_u16 v27, v6 offset:2480
    ds_read_u16_d16_hi v28, v8 offset:10496
    ds_read_u16_d16_hi v29, v8 offset:11152
    ds_read_u16_d16_hi v30, v8 offset:11808
    ds_read_u16_d16_hi v31, v8 offset:12464
    ds_read_u16_d16_hi v32, v6 offset:10752
    ds_read_u16_d16_hi v33, v6 offset:11408
    ds_read_u16_d16_hi v34, v6 offset:12064
    ds_read_u16_d16_hi v35, v6 offset:12720
    ds_read_u16_d16_hi v36, v6 offset:11008
    ds_read_u16_d16_hi v37, v6 offset:11664
    ds_read_u16_d16_hi v38, v6 offset:12320
    ds_read_u16_d16_hi v39, v6 offset:12976
    s_waitcnt lgkmcnt(0)
    v_or3_b32 v16, v16, v28, 1
    v_or_b32 v17, v17, v29
    v_or_b32 v18, v18, v30
    v_or_b32 v19, v19, v31
    v_or3_b32 v20, v20, v32, 1
    v_or_b32 v21, v21, v33
    v_or_b32 v22, v22, v34
    v_or_b32 v23, v23, v35
    v_or3_b32 v24, v24, v36, 1
    v_or_b32 v25, v25, v37
    v_or_b32 v26, v26, v38
    v_or_b32 v27, v27, v39
    s_mov_b32 s81, 0
SY10:
    ds_read_b32 v167, v165 offset:16
    s_add_u32 s81, s81, 1
    s_cmp_gt_u32 s81, 0x400000
    s_cbranch_scc1 SY10_D
    s_waitcnt lgkmcnt(0)
    v_readfirstlane_b32 s80, v167
    s_cmp_ge_u32 s80, 1
    s_cbranch_scc1 SY10_D
    s_sleep 1
    s_branch SY10
SY10_D:
    buffer_store_dwordx4 v[16:19], v9, s[12:15], s21 offen sc0 sc1
    buffer_store_dwordx4 v[20:23], v9, s[12:15], s22 offen sc0 sc1
    v_cmp_gt_u32 vcc, 16, v2
    s_and_saveexec_b64 s[38:39], vcc
    buffer_store_dwordx4 v[24:27], v9, s[12:15], s23 offen sc0 sc1
    s_mov_b64 exec, s[38:39]
    s_mov_b64 exec, 1
    ds_add_u32 v165, v166 offset:36
    s_mov_b64 exec, -1
    s_branch KF_DISP
KF_R9:
    v_lshlrev_b32 v4, 4, v1
    v_mov_b32 v56, -1
    v_mov_b32 v57, -1
    v_mov_b32 v58, -1
    v_mov_b32 v59, -1
    v_mul_u32_u24 v2, 4352, v1
    s_mov_b32 s23, s17
    s_mul_i32 s34, s2, 336
    s_add_u32 s34, s34, 0x1410000
    s_mul_i32 s35, s2, 128
    s_add_u32 s35, s35, 0x1400000
    s_lshl_b32 s41, s18, 10
    s_add_u32 s41, s41, 0x1430000
    s_lshl_b32 s40, s23, 3
    v_lshlrev_b32 v5, 4, v1
    s_add_u32 s40, s40, s41
    s_lshl_b32 s36, s23, 14
    s_lshl_b32 s22, s18, 13
    s_add_u32 s36, s36, s22
    s_add_u32 s37, s36, 4096
    s_lshr_b32 s38, s23, 3
    s_lshl_b32 s38, s38, 14
    s_add_u32 s38, s38, s22
    s_and_b32 s39, s23, 7
    s_lshl_b32 s39, s39, 10
    s_add_u32 s38, s38, s39
    s_add_u32 s38, s38, 0x200000
    s_and_b32 s23, s23, 3
    s_mul_i32 s23, s23, 4352
    s_xor_b32 s43, s41, 3072
    s_add_u32 s41, s41, s23
    s_add_u32 s43, s43, s23
    s_add_u32 s54, s40, 2048
    s_add_u32 s55, s41, 2048
    s_waitcnt lgkmcnt(0)
    s_sub_u32 s84, s84, 400
    s_subb_u32 s85, s85, 0
    v_mov_b32 v12, s84
    v_mov_b32 v13, s85

    s_mov_b32 s4, s30
    s_mov_b32 s5, s31
    s_mov_b32 s6, 0x2000000
    s_mov_b32 s7, 0x00020000
    buffer_store_dwordx4 v[56:59], v4, s[4:7], s36 offen offset:0 sc0 sc1
    buffer_store_dwordx4 v[56:59], v4, s[4:7], s36 offen offset:1024 sc0 sc1
    buffer_store_dwordx4 v[56:59], v4, s[4:7], s36 offen offset:2048 sc0 sc1
    buffer_store_dwordx4 v[56:59], v4, s[4:7], s36 offen offset:3072 sc0 sc1
    buffer_store_dwordx4 v[56:59], v4, s[4:7], s37 offen offset:0 sc0 sc1
    buffer_store_dwordx4 v[56:59], v4, s[4:7], s37 offen offset:1024 sc0 sc1
    buffer_store_dwordx4 v[56:59], v4, s[4:7], s37 offen offset:2048 sc0 sc1
    buffer_store_dwordx4 v[56:59], v4, s[4:7], s37 offen offset:3072 sc0 sc1
    buffer_store_dwordx4 v[56:59], v4, s[4:7], s38 offen sc0 sc1
    s_add_u32 s36, s36, 0x400000
    s_add_u32 s37, s37, 0x400000
    s_add_u32 s38, s38, 0x400000
    s_barrier
    s_waitcnt vmcnt(0)
    s_memrealtime s[82:83]
    s_waitcnt lgkmcnt(0)
    v_mov_b32 v60, s82
    v_mov_b32 v61, s83
    s_mov_b64 exec, 0xf

    buffer_store_dwordx2 v[60:61], v2, s[4:7], s40 offen sc0 sc1
    s_mov_b64 exec, -1
    s_mov_b32 s47, s82
    s_and_b32 s21, s2, 0xf7
    s_cmp_lg_u32 s21, 160
    s_cbranch_scc1 R9_NWH
    s_lshl_b32 s21, s18, 12
    s_add_u32 s21, s21, 0x1428000

    buffer_store_dwordx4 v[56:59], v4, s[4:7], s21 offen offset:0 sc0 sc1
    buffer_store_dwordx4 v[56:59], v4, s[4:7], s21 offen offset:1024 sc0 sc1
    buffer_store_dwordx4 v[56:59], v4, s[4:7], s21 offen offset:2048 sc0 sc1
    buffer_store_dwordx4 v[56:59], v4, s[4:7], s21 offen offset:3072 sc0 sc1
R9_NWH:
    buffer_store_dwordx4 v[56:59], v4, s[4:7], s36 offen offset:0 sc0 sc1
    buffer_store_dwordx4 v[56:59], v4, s[4:7], s36 offen offset:1024 sc0 sc1
    buffer_store_dwordx4 v[56:59], v4, s[4:7], s36 offen offset:2048 sc0 sc1
    buffer_store_dwordx4 v[56:59], v4, s[4:7], s36 offen offset:3072 sc0 sc1
    buffer_store_dwordx4 v[56:59], v4, s[4:7], s37 offen offset:0 sc0 sc1
    buffer_store_dwordx4 v[56:59], v4, s[4:7], s37 offen offset:1024 sc0 sc1
    buffer_store_dwordx4 v[56:59], v4, s[4:7], s37 offen offset:2048 sc0 sc1
    buffer_store_dwordx4 v[56:59], v4, s[4:7], s37 offen offset:3072 sc0 sc1
    buffer_store_dwordx4 v[56:59], v4, s[4:7], s38 offen sc0 sc1
    s_mov_b64 exec, 0x1fffff
    buffer_store_dwordx4 v[56:59], v4, s[4:7], s34 offen sc0 sc1
    s_mov_b64 exec, 0xff
    buffer_store_dwordx4 v[56:59], v4, s[4:7], s35 offen sc0 sc1
    s_mov_b64 exec, -1

    s_lshr_b32 s50, s2, 4
    s_lshl_b32 s50, s50, 3
    s_and_b32 s51, s2, 7
    s_add_u32 s50, s50, s51
    s_lshr_b32 s51, s50, 1
    s_and_b32 s52, s50, 1
    s_mul_i32 s53, s51, 578
    s_and_b32 s53, s53, 0xfffffff0
    s_mul_i32 s52, s52, 295936
    s_add_u32 s53, s53, s52
    v_lshlrev_b32 v4, 4, v1

    s_mov_b32 s8, s26
    s_mov_b32 s9, s27
    s_mov_b32 s10, 0x121000
    s_mov_b32 s11, 0x00020000
    s_mov_b32 s56, s28
    s_mov_b32 s57, s29
    s_mov_b32 s58, 0x121000
    s_mov_b32 s59, 0x00020000
    s_mov_b32 exec_hi, 0x3f
    s_mov_b32 m0, 84544
    buffer_load_dwordx4 v4, s[8:11], s53 offen lds
    s_mov_b32 m0, 95040
    buffer_load_dwordx4 v4, s[56:59], s53 offen lds
    s_add_u32 s53, s53, 36992
    s_mov_b32 m0, 85200
    buffer_load_dwordx4 v4, s[8:11], s53 offen lds
    s_mov_b32 m0, 95696
    buffer_load_dwordx4 v4, s[56:59], s53 offen lds
    s_add_u32 s53, s53, 36992
    s_mov_b32 m0, 85856
    buffer_load_dwordx4 v4, s[8:11], s53 offen lds
    s_mov_b32 m0, 96352
    buffer_load_dwordx4 v4, s[56:59], s53 offen lds
    s_add_u32 s53, s53, 36992
    s_mov_b32 m0, 86512
    buffer_load_dwordx4 v4, s[8:11], s53 offen lds
    s_mov_b32 m0, 97008
    buffer_load_dwordx4 v4, s[56:59], s53 offen lds
    s_add_u32 s53, s53, 480896
    s_mov_b32 m0, 87168
    buffer_load_dwordx4 v4, s[8:11], s53 offen lds
    s_mov_b32 m0, 97664
    buffer_load_dwordx4 v4, s[56:59], s53 offen lds
    s_add_u32 s53, s53, 36992
    s_mov_b32 m0, 87824
    buffer_load_dwordx4 v4, s[8:11], s53 offen lds
    s_mov_b32 m0, 98320
    buffer_load_dwordx4 v4, s[56:59], s53 offen lds
    s_add_u32 s53, s53, 36992
    s_mov_b32 m0, 88480
    buffer_load_dwordx4 v4, s[8:11], s53 offen lds
    s_mov_b32 m0, 98976
    buffer_load_dwordx4 v4, s[56:59], s53 offen lds
    s_add_u32 s53, s53, 36992
    s_mov_b32 m0, 89136
    buffer_load_dwordx4 v4, s[8:11], s53 offen lds
    s_mov_b32 m0, 99632
    buffer_load_dwordx4 v4, s[56:59], s53 offen lds
    s_sub_u32 s53, s53, 554880
    s_mov_b32 m0, 89792
    buffer_load_dwordx4 v4, s[8:11], s53 offen lds
    s_mov_b32 m0, 100288
    buffer_load_dwordx4 v4, s[56:59], s53 offen lds
    s_add_u32 s53, s53, 36992
    s_mov_b32 m0, 90448
    buffer_load_dwordx4 v4, s[8:11], s53 offen lds
    s_mov_b32 m0, 100944
    buffer_load_dwordx4 v4, s[56:59], s53 offen lds
    s_add_u32 s53, s53, 36992
    s_mov_b32 m0, 91104
    buffer_load_dwordx4 v4, s[8:11], s53 offen lds
    s_mov_b32 m0, 101600
    buffer_load_dwordx4 v4, s[56:59], s53 offen lds
    s_add_u32 s53, s53, 36992
    s_mov_b32 m0, 91760
    buffer_load_dwordx4 v4, s[8:11], s53 offen lds
    s_mov_b32 m0, 102256
    buffer_load_dwordx4 v4, s[56:59], s53 offen lds
    s_add_u32 s53, s53, 480896
    s_mov_b32 m0, 92416
    buffer_load_dwordx4 v4, s[8:11], s53 offen lds
    s_mov_b32 m0, 102912
    buffer_load_dwordx4 v4, s[56:59], s53 offen lds
    s_add_u32 s53, s53, 36992
    s_mov_b32 m0, 93072
    buffer_load_dwordx4 v4, s[8:11], s53 offen lds
    s_mov_b32 m0, 103568
    buffer_load_dwordx4 v4, s[56:59], s53 offen lds
    s_add_u32 s53, s53, 36992
    s_mov_b32 m0, 93728
    buffer_load_dwordx4 v4, s[8:11], s53 offen lds
    s_mov_b32 m0, 104224
    buffer_load_dwordx4 v4, s[56:59], s53 offen lds
    s_add_u32 s53, s53, 36992
    s_mov_b32 m0, 94384
    buffer_load_dwordx4 v4, s[8:11], s53 offen lds
    s_mov_b32 m0, 104880
    buffer_load_dwordx4 v4, s[56:59], s53 offen lds
    s_mov_b64 exec, -1
    s_waitcnt vmcnt(32)
    s_memrealtime s[82:83]
    s_waitcnt lgkmcnt(0)
    v_mov_b32 v60, s82
    v_mov_b32 v61, s83
    s_mov_b64 exec, 0xf

    buffer_store_dwordx2 v[60:61], v2, s[4:7], s54 offen sc0 sc1
    s_mov_b64 exec, -1
    s_mov_b32 s80, s47
    s_mov_b32 s63, 0
FA_P:
    buffer_load_dwordx4 v[16:19], v5, s[4:7], s41 offen sc0 sc1
FA_C:
    s_sub_u32 s42, s80, s84
    s_add_u32 s42, s42, 400
    s_waitcnt vmcnt(0)
    v_sub_co_u32 v16, vcc, v16, v12
    v_subb_co_u32 v17, vcc, v17, v13, vcc
    v_sub_co_u32 v18, vcc, v18, v12
    v_subb_co_u32 v19, vcc, v19, v13, vcc
    v_max_u32 v32, v16, v18
    v_lshrrev_b32 v34, 24, v32
    v_or3_b32 v33, v17, v19, v34
    v_cmp_ne_u32 s[44:45], 0, v33
    v_cmp_lt_u32 vcc, s42, v32
    s_add_u32 s63, s63, 1
    s_and_b32 s46, s63, 31
    s_cmp_eq_u32 s46, 0
    s_cbranch_scc1 FA_RF
    s_cmp_lg_u64 s[44:45], 0
    s_cbranch_scc1 FA_NR
    s_cbranch_vccz FA_NR
FA_RF:

    s_memrealtime s[82:83]
    s_waitcnt lgkmcnt(0)
    v_mov_b32 v60, s82
    v_mov_b32 v61, s83
    s_mov_b64 exec, 0xf

    buffer_store_dwordx2 v[60:61], v2, s[4:7], s40 offen sc0 sc1
    buffer_store_dwordx2 v[60:61], v2, s[4:7], s54 offen sc0 sc1
    s_mov_b64 exec, -1
    s_mov_b32 s80, s82
FA_NR:
    s_cmp_gt_u32 s63, 200000
    s_cbranch_scc1 FA_D
    s_cmp_eq_u64 s[44:45], 0
    s_cbranch_scc1 FA_D
    s_sleep 4
    s_branch FA_P
FA_D:

    s_mov_b64 exec, 1
    ds_add_u32 v165, v166 offset:12
    s_mov_b64 exec, -1
    s_mov_b64 exec, 1
    ds_add_u32 v165, v166 offset:8
    s_mov_b64 exec, -1
    s_mov_b32 s63, 0
FB_P:
    buffer_load_dwordx4 v[16:19], v5, s[4:7], s55 offen sc0 sc1
FB_C:
    s_sub_u32 s42, s80, s84
    s_add_u32 s42, s42, 400
    s_waitcnt vmcnt(0)
    v_sub_co_u32 v16, vcc, v16, v12
    v_subb_co_u32 v17, vcc, v17, v13, vcc
    v_sub_co_u32 v18, vcc, v18, v12
    v_subb_co_u32 v19, vcc, v19, v13, vcc
    v_max_u32 v32, v16, v18
    v_lshrrev_b32 v34, 24, v32
    v_or3_b32 v33, v17, v19, v34
    v_cmp_ne_u32 s[44:45], 0, v33
    v_cmp_lt_u32 vcc, s42, v32
    s_add_u32 s63, s63, 1
    s_and_b32 s46, s63, 31
    s_cmp_eq_u32 s46, 0
    s_cbranch_scc1 FB_RF
    s_cmp_lg_u64 s[44:45], 0
    s_cbranch_scc1 FB_NR
    s_cbranch_vccz FB_NR
FB_RF:

    s_memrealtime s[82:83]
    s_waitcnt lgkmcnt(0)
    v_mov_b32 v60, s82
    v_mov_b32 v61, s83
    s_mov_b64 exec, 0xf

    buffer_store_dwordx2 v[60:61], v2, s[4:7], s40 offen sc0 sc1
    buffer_store_dwordx2 v[60:61], v2, s[4:7], s54 offen sc0 sc1
    s_mov_b64 exec, -1
    s_mov_b32 s80, s82
FB_NR:
    s_cmp_gt_u32 s63, 200000
    s_cbranch_scc1 FB_D
    s_cmp_eq_u64 s[44:45], 0
    s_cbranch_scc1 FB_D
    s_sleep 4
    s_branch FB_P
FB_D:

    s_mov_b64 exec, 1
    ds_add_u32 v165, v166 offset:16
    s_mov_b64 exec, -1
    s_getpc_b64 s[48:49]
    s_add_u32 s48, s48, kf_kernel@rel32@lo+4
    s_addc_u32 s49, s49, kf_kernel@rel32@hi+12
    s_lshr_b32 s21, s2, 3
    s_mul_i32 s21, s21, 512

    s_min_u32 s22, s21, CODE_END-kf_kernel-4
    s_load_dword s96, s[48:49], s22
    s_add_u32 s21, s21, 128
    s_min_u32 s22, s21, CODE_END-kf_kernel-4
    s_load_dword s97, s[48:49], s22
    s_add_u32 s21, s21, 128
    s_min_u32 s22, s21, CODE_END-kf_kernel-4
    s_load_dword s98, s[48:49], s22
    s_add_u32 s21, s21, 128
    s_min_u32 s22, s21, CODE_END-kf_kernel-4
    s_load_dword s99, s[48:49], s22
    s_sleep 40
    s_mov_b32 s63, 0
FO_P:
    buffer_load_dwordx4 v[16:19], v5, s[4:7], s43 offen sc0 sc1
FO_C:
    s_sub_u32 s42, s80, s84
    s_add_u32 s42, s42, 400
    s_waitcnt vmcnt(0)
    v_sub_co_u32 v16, vcc, v16, v12
    v_subb_co_u32 v17, vcc, v17, v13, vcc
    v_sub_co_u32 v18, vcc, v18, v12
    v_subb_co_u32 v19, vcc, v19, v13, vcc
    v_max_u32 v32, v16, v18
    v_lshrrev_b32 v34, 24, v32
    v_or3_b32 v33, v17, v19, v34
    v_cmp_ne_u32 s[44:45], 0, v33
    v_cmp_lt_u32 vcc, s42, v32
    s_add_u32 s63, s63, 1
    s_and_b32 s46, s63, 31
    s_cmp_eq_u32 s46, 0
    s_cbranch_scc1 FO_RF
    s_cmp_lg_u64 s[44:45], 0
    s_cbranch_scc1 FO_NR
    s_cbranch_vccz FO_NR
FO_RF:

    s_memrealtime s[82:83]
    s_waitcnt lgkmcnt(0)
    v_mov_b32 v60, s82
    v_mov_b32 v61, s83
    s_mov_b64 exec, 0xf

    buffer_store_dwordx2 v[60:61], v2, s[4:7], s40 offen sc0 sc1
    buffer_store_dwordx2 v[60:61], v2, s[4:7], s54 offen sc0 sc1
    s_mov_b64 exec, -1
    s_mov_b32 s80, s82
FO_NR:
    s_cmp_gt_u32 s63, 200000
    s_cbranch_scc1 FO_D
    s_cmp_eq_u64 s[44:45], 0
    s_cbranch_scc1 FO_D
    s_sleep 4
    s_branch FO_P
FO_D:

    s_mov_b64 exec, 1
    ds_add_u32 v165, v166 offset:104
    s_mov_b64 exec, -1
    s_branch KF_DISP
KF_DISP:

    s_and_b32 s3, s2, 127
    s_lshl_b32 s3, s3, 1
    s_add_u32 s3, s3, s18
    s_and_b32 s33, s20, 3
    s_mov_b32 s34, 0x21340
    s_mov_b32 s35, 0x14a40
    v_mov_b32 v164, v165
    s_cmp_lt_u32 s20, 4
    s_cbranch_scc1 KF_B
    s_cmp_ge_u32 s20, 8
    s_cbranch_scc1 KF_NB
    s_sub_u32 s16, s2, 128
    s_cmp_ge_u32 s16, 32
    s_cbranch_scc1 KF_NB
    s_lshr_b32 s3, s16, 4
    s_lshl_b32 s3, s3, 3
    s_and_b32 s16, s16, 7
    s_add_u32 s3, s3, s16
    s_lshl_b32 s3, s3, 1
    s_add_u32 s3, s3, s18
    s_add_u32 s3, s3, 256
    s_mov_b32 s34, 0x1cf00
    s_mov_b32 s35, 0x16a40
    v_add_u32 v164, 4, v165
KF_B:
    s_setprio 2

    v_and_b32 v3, 15, v1
    v_lshrrev_b32 v4, 4, v1
    s_lshl_b32 s22, s33, 4
    v_add_u32 v7, s22, v3
    v_cvt_f32_u32 v16, v7
    v_cvt_f32_u32 v17, v4
    v_cvt_f32_u32 v18, v3
    s_mov_b32 s48, 0x80008000
    s_mov_b32 s49, 0x80000000
    v_mul_f32 v19, 0x3c800000, v16
    v_mul_f32 v20, 0x41800000, v19
    v_mul_f32 v20, v20, v17
    v_add_f32 v21, v20, v19
    v_fma_f32 v22, 2.0, v19, v20
    v_add_f32 v23, v22, v19
    v_add_f32 v24, v19, v19
    v_cos_f32 v24, v24

    v_cos_f32 v28, v20
    v_cos_f32 v29, v21
    v_cos_f32 v30, v22
    v_cos_f32 v31, v23
    v_sin_f32 v32, v20
    v_sin_f32 v33, v21
    v_sin_f32 v34, v22
    v_sin_f32 v35, v23
    v_add_f32 v24, v24, v24
    v_mul_f32 v19, 0x3d000000, v18
    v_mul_f32 v20, 4.0, v19
    v_mul_f32 v20, v20, v17
    v_add_f32 v21, v20, v19
    v_fma_f32 v22, 2.0, v19, v20
    v_add_f32 v23, v22, v19

    v_cos_f32 v36, v20
    v_cos_f32 v37, v21
    v_cos_f32 v38, v22
    v_cos_f32 v39, v23
    v_sin_f32 v40, v20
    v_sin_f32 v41, v21
    v_sin_f32 v42, v22
    v_sin_f32 v43, v23
    v_cvt_pk_bf16_f32 v50, v28, v29
    v_cvt_pk_bf16_f32 v52, v32, v33
    v_pk_fma_f32 v[28:29], v[30:31], v[24:25], v[28:29] op_sel_hi:[1,0,1] neg_lo:[0,0,1] neg_hi:[0,0,1]
    v_cvt_pk_bf16_f32 v51, v30, v31
    v_pk_fma_f32 v[32:33], v[34:35], v[24:25], v[32:33] op_sel_hi:[1,0,1] neg_lo:[0,0,1] neg_hi:[0,0,1]
    v_cvt_pk_bf16_f32 v53, v34, v35
    v_pk_fma_f32 v[30:31], v[28:29], v[24:25], v[30:31] op_sel_hi:[1,0,1] neg_lo:[0,0,1] neg_hi:[0,0,1]
    v_cvt_pk_bf16_f32 v56, v28, v29
    v_pk_fma_f32 v[34:35], v[32:33], v[24:25], v[34:35] op_sel_hi:[1,0,1] neg_lo:[0,0,1] neg_hi:[0,0,1]
    v_cvt_pk_bf16_f32 v58, v32, v33
    v_pk_fma_f32 v[28:29], v[30:31], v[24:25], v[28:29] op_sel_hi:[1,0,1] neg_lo:[0,0,1] neg_hi:[0,0,1]
    v_cvt_pk_bf16_f32 v57, v30, v31
    v_pk_fma_f32 v[32:33], v[34:35], v[24:25], v[32:33] op_sel_hi:[1,0,1] neg_lo:[0,0,1] neg_hi:[0,0,1]
    v_cvt_pk_bf16_f32 v59, v34, v35
    v_pk_fma_f32 v[30:31], v[28:29], v[24:25], v[30:31] op_sel_hi:[1,0,1] neg_lo:[0,0,1] neg_hi:[0,0,1]
    v_cvt_pk_bf16_f32 v62, v28, v29
    v_pk_fma_f32 v[34:35], v[32:33], v[24:25], v[34:35] op_sel_hi:[1,0,1] neg_lo:[0,0,1] neg_hi:[0,0,1]
    v_cvt_pk_bf16_f32 v64, v32, v33
    v_pk_fma_f32 v[28:29], v[30:31], v[24:25], v[28:29] op_sel_hi:[1,0,1] neg_lo:[0,0,1] neg_hi:[0,0,1]
    v_cvt_pk_bf16_f32 v63, v30, v31
    v_pk_fma_f32 v[32:33], v[34:35], v[24:25], v[32:33] op_sel_hi:[1,0,1] neg_lo:[0,0,1] neg_hi:[0,0,1]
    v_cvt_pk_bf16_f32 v65, v34, v35
    v_pk_fma_f32 v[30:31], v[28:29], v[24:25], v[30:31] op_sel_hi:[1,0,1] neg_lo:[0,0,1] neg_hi:[0,0,1]
    v_cvt_pk_bf16_f32 v68, v28, v29
    v_pk_fma_f32 v[34:35], v[32:33], v[24:25], v[34:35] op_sel_hi:[1,0,1] neg_lo:[0,0,1] neg_hi:[0,0,1]
    v_cvt_pk_bf16_f32 v70, v32, v33
    v_cvt_pk_bf16_f32 v69, v30, v31
    v_cvt_pk_bf16_f32 v71, v34, v35
    v_xor_b32 v48, s48, v52
    v_xor_b32 v49, s48, v53
    v_xor_b32 v54, s48, v58
    v_xor_b32 v55, s48, v59
    v_xor_b32 v60, s48, v64
    v_xor_b32 v61, s48, v65
    v_xor_b32 v66, s48, v70
    v_xor_b32 v67, s48, v71
    v_and_b32 v19, 1, v1
    v_mul_lo_u32 v19, v19, s48
    v_cvt_pk_bf16_f32 v72, v36, v37
    v_cvt_pk_bf16_f32 v73, v38, v39
    v_cvt_pk_bf16_f32 v80, v40, v41
    v_cvt_pk_bf16_f32 v81, v42, v43
    v_mul_f32 v20, 0x3a000000, v16
    v_mul_f32 v21, 4.0, v20
    v_mul_f32 v21, v21, v17

    v_xor_b32 v74, v19, v72
    v_xor_b32 v75, v19, v73
    v_xor_b32 v76, s49, v72
    v_xor_b32 v77, s49, v73
    v_xor_b32 v78, s49, v74
    v_xor_b32 v79, s49, v75
    v_xor_b32 v82, v19, v80
    v_xor_b32 v83, v19, v81
    v_xor_b32 v84, s49, v80
    v_xor_b32 v85, s49, v81
    v_xor_b32 v86, s49, v82
    v_xor_b32 v87, s49, v83
    v_xor_b32 v88, s48, v80
    v_xor_b32 v89, s48, v81
    v_xor_b32 v90, s48, v82
    v_xor_b32 v91, s48, v83
    v_xor_b32 v92, s48, v84
    v_xor_b32 v93, s48, v85
    v_xor_b32 v94, s48, v86
    v_xor_b32 v95, s48, v87
    v_mov_b32 v24, v21
    v_fmamk_f32 v25, v20, 0x3f800000, v21
    v_fmamk_f32 v26, v20, 0x40000000, v21
    v_fmamk_f32 v27, v20, 0x40400000, v21
    v_fmamk_f32 v28, v20, 0x41800000, v21
    v_fmamk_f32 v29, v20, 0x41880000, v21
    v_fmamk_f32 v30, v20, 0x41900000, v21
    v_fmamk_f32 v31, v20, 0x41980000, v21
    v_cos_f32 v96, v24
    v_sin_f32 v100, v24
    v_cos_f32 v97, v25
    v_sin_f32 v101, v25
    v_cos_f32 v98, v26
    v_sin_f32 v102, v26
    v_cos_f32 v99, v27
    v_sin_f32 v103, v27
    v_cos_f32 v104, v28
    v_sin_f32 v108, v28
    v_cos_f32 v105, v29
    v_sin_f32 v109, v29
    v_cos_f32 v106, v30
    v_sin_f32 v110, v30
    v_cos_f32 v107, v31
    v_sin_f32 v111, v31
    s_lshl_b32 s16, s3, 13
    s_add_u32 s17, s16, 4096

    s_mov_b32 s40, 0x35e38e39
    s_mov_b32 s22, 0x35638e39
    s_cmp_eq_u32 s3, 0
    s_cselect_b32 s40, s22, s40
    s_mov_b32 s41, s40
    s_and_b32 s22, s3, 3
    s_cmp_eq_u32 s22, 3
    s_cselect_b32 s22, 0, 0x80000000
    s_xor_b32 s42, s40, s22
    s_mov_b32 s43, s42
    v_mul_u32_u24 v12, 72, v7
    v_lshl_add_u32 v12, v4, 3, v12
    v_add_u32 v12, s34, v12
    v_lshlrev_b32 v13, 4, v4
    v_bfe_u32 v14, v1, 2, 2
    v_add_u32 v13, v13, v14
    v_mul_u32_u24 v13, 72, v13
    v_and_b32 v14, 3, v1
    v_lshl_add_u32 v13, v14, 3, v13
    v_add_u32 v13, s34, v13
    v_lshlrev_b32 v14, 6, v7
    v_lshl_add_u32 v14, v4, 4, v14
    s_mov_b32 s63, 0

    s_mov_b32 s4, s30
    s_mov_b32 s5, s31
    s_mov_b32 s6, 0x240000
    s_mov_b32 s7, 0x00020000
    s_add_u32 s12, s30, 0x400000
    s_addc_u32 s13, s31, 0
    s_mov_b32 s14, 0x240000
    s_mov_b32 s15, 0x00020000
    v_lshlrev_b32 v6, 7, v7
    v_lshl_add_u32 v6, v4, 5, v6

    s_add_u32 s18, s34, 9216
    v_mul_u32_u24 v15, 1032, v4
    v_bfe_u32 v2, v1, 2, 2
    v_lshl_add_u32 v15, v2, 6, v15
    v_and_b32 v2, 3, v1
    v_lshl_add_u32 v15, v2, 4, v15
    v_add_u32 v15, s18, v15
    s_lshl_b32 s44, s33, 3
    s_add_u32 s18, s18, s44
    v_add_u32 v2, s18, v14
    v_add_u32 v5, 4128, v2

    s_mov_b32 s81, 0
SY11:
    ds_read_b32 v167, v165 offset:36
    s_add_u32 s81, s81, 1
    s_cmp_gt_u32 s81, 0x400000
    s_cbranch_scc1 SY11_D
    s_waitcnt lgkmcnt(0)
    v_readfirstlane_b32 s80, v167
    s_cmp_ge_u32 s80, 4
    s_cbranch_scc1 SY11_D
    s_sleep 1
    s_branch SY11
SY11_D:
    s_mov_b32 s81, 0
SY12:
    ds_read_b32 v167, v165 offset:16
    s_add_u32 s81, s81, 1
    s_cmp_gt_u32 s81, 0x400000
    s_cbranch_scc1 SY12_D
    s_waitcnt lgkmcnt(0)
    v_readfirstlane_b32 s80, v167
    s_cmp_ge_u32 s80, 1
    s_cbranch_scc1 SY12_D
    s_sleep 1
    s_branch SY12
SY12_D:
    s_mov_b32 s63, 0
KF_Z_P:
    buffer_load_dwordx4 v[16:19], v14, s[4:7], s16 offen sc0 sc1
    buffer_load_dwordx4 v[20:23], v14, s[4:7], s17 offen sc0 sc1
KF_Z_C:
    s_waitcnt vmcnt(0)
    v_max_u32 v9, v16, v20
    v_cmp_eq_u32 vcc, -1, v9
    s_add_u32 s63, s63, 1
    s_cmp_gt_u32 s63, 200000
    s_cbranch_scc1 KF_Z_D
    s_and_b64 exec, exec, vcc
    s_cbranch_execz KF_Z_D
    s_sleep 1
    s_branch KF_Z_P
KF_Z_D:
    s_mov_b64 exec, -1

    ds_write2_b64 v2, v[16:17], v[18:19] offset0:0 offset1:1
    ds_write2_b64 v5, v[20:21], v[22:23] offset0:0 offset1:1
    s_mov_b64 exec, 1
    ds_add_u32 v164, v166 offset:80
    s_mov_b64 exec, -1
    buffer_load_dwordx4 v[112:115], v6, s[12:15], s16 offen sc0 sc1
    buffer_load_dwordx4 v[116:119], v6, s[12:15], s16 offen offset:16 sc0 sc1
    s_mov_b32 s81, 0
SY13:
    ds_read_b32 v167, v164 offset:80
    s_add_u32 s81, s81, 1
    s_cmp_gt_u32 s81, 0x400000
    s_cbranch_scc1 SY13_D
    s_waitcnt lgkmcnt(0)
    v_readfirstlane_b32 s80, v167
    s_cmp_ge_u32 s80, 4
    s_cbranch_scc0 SY13
SY13_D:
    ds_read_b64_tr_b16 v[16:17], v15 offset:0
    ds_read_b64_tr_b16 v[18:19], v15 offset:8
    ds_read_b64_tr_b16 v[20:21], v15 offset:256
    ds_read_b64_tr_b16 v[22:23], v15 offset:264
    ds_read_b64_tr_b16 v[24:25], v15 offset:512
    ds_read_b64_tr_b16 v[26:27], v15 offset:520
    ds_read_b64_tr_b16 v[28:29], v15 offset:768
    ds_read_b64_tr_b16 v[30:31], v15 offset:776
    ds_read_b64_tr_b16 v[32:33], v15 offset:4128
    ds_read_b64_tr_b16 v[34:35], v15 offset:4136
    ds_read_b64_tr_b16 v[36:37], v15 offset:4384
    ds_read_b64_tr_b16 v[38:39], v15 offset:4392
    ds_read_b64_tr_b16 v[40:41], v15 offset:4640
    ds_read_b64_tr_b16 v[42:43], v15 offset:4648
    ds_read_b64_tr_b16 v[44:45], v15 offset:4896
    ds_read_b64_tr_b16 v[46:47], v15 offset:4904
    s_mov_b64 exec, 1
    ds_add_u32 v165, v166 offset:32
    s_mov_b64 exec, -1
    s_waitcnt lgkmcnt(14)
    v_mfma_f32_16x16x32_bf16 v[120:123], v[16:19], v[50:53], 0
    v_mfma_f32_16x16x32_bf16 v[128:131], v[16:19], v[48:51], 0
    s_waitcnt lgkmcnt(13)
    v_mfma_f32_16x16x32_bf16 v[120:123], v[20:23], v[56:59], v[120:123]
    v_mfma_f32_16x16x32_bf16 v[128:131], v[20:23], v[54:57], v[128:131]
    s_waitcnt lgkmcnt(11)
    v_mfma_f32_16x16x32_bf16 v[120:123], v[24:27], v[62:65], v[120:123]
    v_mfma_f32_16x16x32_bf16 v[128:131], v[24:27], v[60:63], v[128:131]
    s_waitcnt lgkmcnt(9)
    v_mfma_f32_16x16x32_bf16 v[120:123], v[28:31], v[68:71], v[120:123]
    v_mfma_f32_16x16x32_bf16 v[128:131], v[28:31], v[66:69], v[128:131]
    s_waitcnt lgkmcnt(7)
    v_mfma_f32_16x16x32_bf16 v[124:127], v[32:35], v[50:53], 0
    v_mfma_f32_16x16x32_bf16 v[132:135], v[32:35], v[48:51], 0
    s_waitcnt lgkmcnt(5)
    v_mfma_f32_16x16x32_bf16 v[124:127], v[36:39], v[56:59], v[124:127]
    v_mfma_f32_16x16x32_bf16 v[132:135], v[36:39], v[54:57], v[132:135]
    s_waitcnt lgkmcnt(3)
    v_mfma_f32_16x16x32_bf16 v[124:127], v[40:43], v[62:65], v[124:127]
    v_mfma_f32_16x16x32_bf16 v[132:135], v[40:43], v[60:63], v[132:135]
    s_waitcnt lgkmcnt(1)
    v_mfma_f32_16x16x32_bf16 v[124:127], v[44:47], v[68:71], v[124:127]
    v_mfma_f32_16x16x32_bf16 v[132:135], v[44:47], v[66:69], v[132:135]
    v_pk_mul_f32 v[8:9], v[120:121], v[96:97]
    v_pk_mul_f32 v[10:11], v[128:129], v[96:97]
    v_pk_fma_f32 v[8:9], v[128:129], v[100:101], v[8:9]
    v_pk_fma_f32 v[10:11], v[120:121], v[100:101], v[10:11] neg_lo:[1,0,0] neg_hi:[1,0,0]
    v_cvt_pk_bf16_f32 v136, v8, v9
    v_cvt_pk_bf16_f32 v140, v10, v11
    v_pk_mul_f32 v[8:9], v[122:123], v[98:99]
    v_pk_mul_f32 v[10:11], v[130:131], v[98:99]
    v_pk_fma_f32 v[8:9], v[130:131], v[102:103], v[8:9]
    v_pk_fma_f32 v[10:11], v[122:123], v[102:103], v[10:11] neg_lo:[1,0,0] neg_hi:[1,0,0]
    v_cvt_pk_bf16_f32 v137, v8, v9
    v_cvt_pk_bf16_f32 v141, v10, v11
    v_pk_mul_f32 v[8:9], v[124:125], v[104:105]
    v_pk_mul_f32 v[10:11], v[132:133], v[104:105]
    v_pk_fma_f32 v[8:9], v[132:133], v[108:109], v[8:9]
    v_pk_fma_f32 v[10:11], v[124:125], v[108:109], v[10:11] neg_lo:[1,0,0] neg_hi:[1,0,0]
    v_cvt_pk_bf16_f32 v138, v8, v9
    v_cvt_pk_bf16_f32 v142, v10, v11
    v_pk_mul_f32 v[8:9], v[126:127], v[106:107]
    v_pk_mul_f32 v[10:11], v[134:135], v[106:107]
    v_pk_fma_f32 v[8:9], v[134:135], v[110:111], v[8:9]
    v_pk_fma_f32 v[10:11], v[126:127], v[110:111], v[10:11] neg_lo:[1,0,0] neg_hi:[1,0,0]
    v_cvt_pk_bf16_f32 v139, v8, v9
    v_cvt_pk_bf16_f32 v143, v10, v11
    s_nop 1
    v_mfma_f32_16x16x32_bf16 v[120:123], v[72:75], v[136:139], 0
    v_mfma_f32_16x16x32_bf16 v[128:131], v[88:91], v[136:139], 0
    v_mfma_f32_16x16x32_bf16 v[124:127], v[76:79], v[136:139], 0
    v_mfma_f32_16x16x32_bf16 v[132:135], v[92:95], v[136:139], 0
    v_mfma_f32_16x16x32_bf16 v[120:123], v[80:83], v[140:143], v[120:123]
    v_mfma_f32_16x16x32_bf16 v[128:131], v[72:75], v[140:143], v[128:131]
    v_mfma_f32_16x16x32_bf16 v[124:127], v[84:87], v[140:143], v[124:127]
    v_mfma_f32_16x16x32_bf16 v[132:135], v[76:79], v[140:143], v[132:135]
    s_mov_b32 s63, 0
    s_branch KF_W_C
    s_mov_b32 s63, 0
KF_W_P:
    buffer_load_dwordx4 v[112:115], v6, s[12:15], s16 offen sc0 sc1
    buffer_load_dwordx4 v[116:119], v6, s[12:15], s16 offen offset:16 sc0 sc1
KF_W_C:
    s_waitcnt vmcnt(0)
    v_max_u32 v9, v112, v116
    v_cmp_eq_u32 vcc, -1, v9
    s_add_u32 s63, s63, 1
    s_cmp_gt_u32 s63, 200000
    s_cbranch_scc1 KF_W_D
    s_and_b64 exec, exec, vcc
    s_cbranch_execz KF_W_D
    s_nop 0
    s_branch KF_W_P
KF_W_D:
    s_mov_b64 exec, -1

    v_lshlrev_b32 v16, 16, v112
    v_and_b32 v24, 0xffff0000, v112
    v_lshlrev_b32 v17, 16, v113
    v_and_b32 v25, 0xffff0000, v113
    v_lshlrev_b32 v18, 16, v114
    v_and_b32 v26, 0xffff0000, v114
    v_lshlrev_b32 v19, 16, v115
    v_and_b32 v27, 0xffff0000, v115
    v_lshlrev_b32 v20, 16, v116
    v_and_b32 v28, 0xffff0000, v116
    v_lshlrev_b32 v21, 16, v117
    v_and_b32 v29, 0xffff0000, v117
    v_lshlrev_b32 v22, 16, v118
    v_and_b32 v30, 0xffff0000, v118
    v_lshlrev_b32 v23, 16, v119
    v_and_b32 v31, 0xffff0000, v119
    v_pk_mul_f32 v[8:9], v[120:121], v[16:17]
    v_pk_mul_f32 v[10:11], v[128:129], v[16:17]
    v_pk_fma_f32 v[8:9], v[128:129], v[24:25], v[8:9] neg_lo:[1,0,0] neg_hi:[1,0,0]
    v_pk_fma_f32 v[10:11], v[120:121], v[24:25], v[10:11]
    v_cvt_pk_bf16_f32 v136, v8, v9
    v_cvt_pk_bf16_f32 v140, v10, v11
    v_pk_mul_f32 v[8:9], v[122:123], v[18:19]
    v_pk_mul_f32 v[10:11], v[130:131], v[18:19]
    v_pk_fma_f32 v[8:9], v[130:131], v[26:27], v[8:9] neg_lo:[1,0,0] neg_hi:[1,0,0]
    v_pk_fma_f32 v[10:11], v[122:123], v[26:27], v[10:11]
    v_cvt_pk_bf16_f32 v137, v8, v9
    v_cvt_pk_bf16_f32 v141, v10, v11
    v_pk_mul_f32 v[8:9], v[124:125], v[20:21]
    v_pk_mul_f32 v[10:11], v[132:133], v[20:21]
    v_pk_fma_f32 v[8:9], v[132:133], v[28:29], v[8:9] neg_lo:[1,0,0] neg_hi:[1,0,0]
    v_pk_fma_f32 v[10:11], v[124:125], v[28:29], v[10:11]
    v_cvt_pk_bf16_f32 v138, v8, v9
    v_cvt_pk_bf16_f32 v142, v10, v11
    v_pk_mul_f32 v[8:9], v[126:127], v[22:23]
    v_pk_mul_f32 v[10:11], v[134:135], v[22:23]
    v_pk_fma_f32 v[8:9], v[134:135], v[30:31], v[8:9] neg_lo:[1,0,0] neg_hi:[1,0,0]
    v_pk_fma_f32 v[10:11], v[126:127], v[30:31], v[10:11]
    v_cvt_pk_bf16_f32 v139, v8, v9
    v_cvt_pk_bf16_f32 v143, v10, v11
    s_nop 1
    v_mfma_f32_16x16x32_bf16 v[120:123], v[72:75], v[136:139], 0
    v_mfma_f32_16x16x32_bf16 v[128:131], v[80:83], v[136:139], 0
    v_mfma_f32_16x16x32_bf16 v[124:127], v[76:79], v[136:139], 0
    v_mfma_f32_16x16x32_bf16 v[132:135], v[84:87], v[136:139], 0
    v_mfma_f32_16x16x32_bf16 v[120:123], v[88:91], v[140:143], v[120:123]
    v_mfma_f32_16x16x32_bf16 v[128:131], v[72:75], v[140:143], v[128:131]
    v_mfma_f32_16x16x32_bf16 v[124:127], v[92:95], v[140:143], v[124:127]
    v_mfma_f32_16x16x32_bf16 v[132:135], v[76:79], v[140:143], v[132:135]
    s_nop 7
    s_nop 3
    v_pk_mul_f32 v[8:9], v[120:121], v[96:97]
    v_pk_mul_f32 v[10:11], v[128:129], v[96:97] neg_lo:[1,0] neg_hi:[1,0]
    v_pk_fma_f32 v[8:9], v[128:129], v[100:101], v[8:9] neg_lo:[1,0,0] neg_hi:[1,0,0]
    v_pk_fma_f32 v[10:11], v[120:121], v[100:101], v[10:11] neg_lo:[1,0,0] neg_hi:[1,0,0]
    v_cvt_pk_bf16_f32 v136, v8, v9
    v_cvt_pk_bf16_f32 v140, v10, v11
    v_pk_mul_f32 v[8:9], v[122:123], v[98:99]
    v_pk_mul_f32 v[10:11], v[130:131], v[98:99] neg_lo:[1,0] neg_hi:[1,0]
    v_pk_fma_f32 v[8:9], v[130:131], v[102:103], v[8:9] neg_lo:[1,0,0] neg_hi:[1,0,0]
    v_pk_fma_f32 v[10:11], v[122:123], v[102:103], v[10:11] neg_lo:[1,0,0] neg_hi:[1,0,0]
    v_cvt_pk_bf16_f32 v137, v8, v9
    v_cvt_pk_bf16_f32 v141, v10, v11
    v_pk_mul_f32 v[8:9], v[124:125], v[104:105]
    v_pk_mul_f32 v[10:11], v[132:133], v[104:105] neg_lo:[1,0] neg_hi:[1,0]
    v_pk_fma_f32 v[8:9], v[132:133], v[108:109], v[8:9] neg_lo:[1,0,0] neg_hi:[1,0,0]
    v_pk_fma_f32 v[10:11], v[124:125], v[108:109], v[10:11] neg_lo:[1,0,0] neg_hi:[1,0,0]
    v_cvt_pk_bf16_f32 v138, v8, v9
    v_cvt_pk_bf16_f32 v142, v10, v11
    v_pk_mul_f32 v[8:9], v[126:127], v[106:107]
    v_pk_mul_f32 v[10:11], v[134:135], v[106:107] neg_lo:[1,0] neg_hi:[1,0]
    v_pk_fma_f32 v[8:9], v[134:135], v[110:111], v[8:9] neg_lo:[1,0,0] neg_hi:[1,0,0]
    v_pk_fma_f32 v[10:11], v[126:127], v[110:111], v[10:11] neg_lo:[1,0,0] neg_hi:[1,0,0]
    v_cvt_pk_bf16_f32 v139, v8, v9
    v_cvt_pk_bf16_f32 v143, v10, v11
    ds_write_b64 v12, v[136:137] offset:0
    ds_write_b64 v12, v[140:141] offset:4608
    ds_write_b64 v12, v[138:139] offset:32
    ds_write_b64 v12, v[142:143] offset:4640
    s_mov_b64 exec, 1
    ds_add_u32 v164, v166 offset:20
    s_mov_b64 exec, -1
    s_mov_b32 s81, 0
SY14:
    ds_read_b32 v167, v164 offset:20
    s_add_u32 s81, s81, 1
    s_cmp_gt_u32 s81, 0x400000
    s_cbranch_scc1 SY14_D
    s_waitcnt lgkmcnt(0)
    v_readfirstlane_b32 s80, v167
    s_cmp_ge_u32 s80, 4
    s_cbranch_scc0 SY14
SY14_D:
    ds_read_b64_tr_b16 v[16:17], v13 offset:0
    ds_read_b64_tr_b16 v[18:19], v13 offset:4608
    ds_read_b64_tr_b16 v[20:21], v13 offset:288
    ds_read_b64_tr_b16 v[22:23], v13 offset:4896
    ds_read_b64_tr_b16 v[24:25], v13 offset:576
    ds_read_b64_tr_b16 v[26:27], v13 offset:5184
    ds_read_b64_tr_b16 v[28:29], v13 offset:864
    ds_read_b64_tr_b16 v[30:31], v13 offset:5472
    ds_read_b64_tr_b16 v[32:33], v13 offset:32
    ds_read_b64_tr_b16 v[34:35], v13 offset:4640
    ds_read_b64_tr_b16 v[36:37], v13 offset:320
    ds_read_b64_tr_b16 v[38:39], v13 offset:4928
    ds_read_b64_tr_b16 v[40:41], v13 offset:608
    ds_read_b64_tr_b16 v[42:43], v13 offset:5216
    ds_read_b64_tr_b16 v[44:45], v13 offset:896
    ds_read_b64_tr_b16 v[46:47], v13 offset:5504
    s_waitcnt lgkmcnt(14)
    v_mfma_f32_16x16x32_bf16 v[120:123], v[16:19], v[50:53], 0
    v_mfma_f32_16x16x32_bf16 v[128:131], v[16:19], v[48:51], 0
    s_waitcnt lgkmcnt(12)
    v_mfma_f32_16x16x32_bf16 v[120:123], v[20:23], v[56:59], v[120:123]
    v_mfma_f32_16x16x32_bf16 v[128:131], v[20:23], v[54:57], v[128:131]
    s_waitcnt lgkmcnt(10)
    v_mfma_f32_16x16x32_bf16 v[120:123], v[24:27], v[62:65], v[120:123]
    v_mfma_f32_16x16x32_bf16 v[128:131], v[24:27], v[60:63], v[128:131]
    s_waitcnt lgkmcnt(8)
    v_mfma_f32_16x16x32_bf16 v[120:123], v[28:31], v[68:71], v[120:123]
    v_mfma_f32_16x16x32_bf16 v[128:131], v[28:31], v[66:69], v[128:131]
    s_waitcnt lgkmcnt(6)
    v_mfma_f32_16x16x32_bf16 v[124:127], v[32:35], v[50:53], 0
    v_mfma_f32_16x16x32_bf16 v[132:135], v[32:35], v[48:51], 0
    s_waitcnt lgkmcnt(4)
    v_mfma_f32_16x16x32_bf16 v[124:127], v[36:39], v[56:59], v[124:127]
    v_mfma_f32_16x16x32_bf16 v[132:135], v[36:39], v[54:57], v[132:135]
    s_waitcnt lgkmcnt(2)
    v_mfma_f32_16x16x32_bf16 v[124:127], v[40:43], v[62:65], v[124:127]
    v_mfma_f32_16x16x32_bf16 v[132:135], v[40:43], v[60:63], v[132:135]
    s_waitcnt lgkmcnt(0)
    v_mfma_f32_16x16x32_bf16 v[124:127], v[44:47], v[68:71], v[124:127]
    v_mfma_f32_16x16x32_bf16 v[132:135], v[44:47], v[66:69], v[132:135]
    v_pk_mul_f32 v[120:121], v[120:121], s[40:41]
    v_pk_mul_f32 v[128:129], v[128:129], s[42:43]
    v_cvt_pk_bf16_f32 v136, v120, v121
    v_cvt_pk_bf16_f32 v138, v128, v129
    v_pk_mul_f32 v[122:123], v[122:123], s[40:41]
    v_pk_mul_f32 v[130:131], v[130:131], s[42:43]
    v_cvt_pk_bf16_f32 v137, v122, v123
    v_cvt_pk_bf16_f32 v139, v130, v131
    v_and_b32 v136, -2, v136
    buffer_store_dwordx4 v[136:139], v14, s[12:15], s16 offen sc0 sc1
    s_nop 1
    v_pk_mul_f32 v[124:125], v[124:125], s[40:41]
    v_pk_mul_f32 v[132:133], v[132:133], s[42:43]
    v_cvt_pk_bf16_f32 v140, v124, v125
    v_cvt_pk_bf16_f32 v142, v132, v133
    v_pk_mul_f32 v[126:127], v[126:127], s[40:41]
    v_pk_mul_f32 v[134:135], v[134:135], s[42:43]
    v_cvt_pk_bf16_f32 v141, v126, v127
    v_cvt_pk_bf16_f32 v143, v134, v135
    v_and_b32 v140, -2, v140
    buffer_store_dwordx4 v[140:143], v14, s[12:15], s17 offen sc0 sc1
    s_mov_b64 exec, 1
    ds_add_u32 v165, v166 offset:28
    s_mov_b64 exec, -1
KF_NB:
    s_cmp_ge_u32 s2, 128
    s_cbranch_scc1 KF_D

KF_C:
    s_setprio 0

    s_mov_b32 s101, s2
    s_mov_b32 s2, s100

    s_load_dwordx2 s[28:29], s[0:1], 64
    s_load_dwordx4 s[24:27], s[0:1], 40
    v_lshlrev_b32 v2, 4, v0
    s_and_b32 s16, s2, 1
    s_lshl_b32 s16, s16, 12
    s_lshr_b32 s17, s2, 1
    s_lshl_b32 s17, s17, 6
    s_add_u32 s16, s16, s17
    s_add_u32 s17, s16, 8192
    v_lshrrev_b32 v9, 2, v0
    v_lshlrev_b32 v10, 14, v9
    v_and_b32 v11, 3, v0
    v_lshl_add_u32 v101, v11, 4, v10

    s_mov_b32 s4, s30
    s_mov_b32 s5, s31
    s_mov_b32 s6, 0x240000
    s_mov_b32 s7, 0x00020000
    s_cmp_ge_u32 s20, 4
    s_cbranch_scc1 C_NZ

    s_mov_b32 s81, 0
SY15:
    ds_read_b32 v167, v165 offset:104
    s_add_u32 s81, s81, 1
    s_cmp_gt_u32 s81, 0x400000
    s_cbranch_scc1 SY15_D
    s_waitcnt lgkmcnt(0)
    v_readfirstlane_b32 s80, v167
    s_cmp_ge_u32 s80, 1
    s_cbranch_scc1 SY15_D
    s_sleep 1
    s_branch SY15
SY15_D:
    buffer_load_dwordx4 v[56:59], v101, s[4:7], s16 offen sc0 sc1
    buffer_load_dwordx4 v[60:63], v101, s[4:7], s17 offen sc0 sc1
C_NZ:
    v_and_b32 v3, 31, v1
    v_mul_u32_u24 v3, 12, v3
    v_lshrrev_b32 v4, 5, v1
    s_lshl_b32 s21, s20, 1
    v_add_u32 v4, s21, v4
    s_lshl_b32 s22, s2, 4
    v_add_u32 v5, s22, v4
    v_mul_u32_u24 v6, 1152, v5
    v_add_u32 v6, v6, v3
    v_mul_u32_u24 v7, 1168, v4
    v_add_u32 v7, v7, v3
    v_lshrrev_b32 v9, 4, v1
    v_mul_u32_u24 v10, 2312, v9
    v_bfe_u32 v11, v1, 2, 2
    v_lshl_add_u32 v10, v11, 6, v10
    v_and_b32 v11, 3, v1
    v_lshl_add_u32 v100, v11, 4, v10
    s_waitcnt lgkmcnt(0)

    s_add_u32 s12, s30, 0x400000
    s_addc_u32 s13, s31, 0
    s_mov_b32 s14, 0x240000
    s_mov_b32 s15, 0x00020000
    s_add_u32 s48, s30, 0x1400000
    s_addc_u32 s49, s31, 0
    s_mov_b32 s50, 0x8000
    s_mov_b32 s51, 0x00020000
    s_mov_b32 s36, s28
    s_mov_b32 s37, s29
    s_mov_b32 s38, 0x240000
    s_mov_b32 s39, 0x00020000
    s_add_u32 s40, s30, 0x1428000
    s_addc_u32 s41, s31, 0
    s_mov_b32 s42, 0x2000
    s_mov_b32 s43, 0x00020000
    s_cmp_lg_u32 s20, 9
    s_cbranch_scc1 C_TAB
    v_lshlrev_b32 v8, 4, v1
    s_and_b32 s21, s2, 3
    s_lshl_b32 s21, s21, 10
    s_add_u32 s22, s21, 4096
    s_mov_b32 s56, -1
    s_mov_b32 s57, 0x1f

    s_mov_b64 exec, s[56:57]
    s_mov_b32 s63, 0
C_WH_P:
    buffer_load_dwordx4 v[16:19], v8, s[40:43], s21 offen sc0 sc1
    buffer_load_dwordx4 v[20:23], v8, s[40:43], s22 offen sc0 sc1
C_WH_C:
    s_waitcnt vmcnt(0)
    v_cmp_eq_u32 vcc, 36, v1
    v_max3_u32 v10, v17, v18, v19
    v_max3_u32 v10, v10, v21, v22
    v_max3_u32 v10, v10, v20, v23
    v_cndmask_b32 v10, v10, 0, vcc
    v_max_u32 v10, v10, v16
    v_cmp_eq_u32 vcc, -1, v10

    s_add_u32 s63, s63, 1
    s_cmp_gt_u32 s63, 200000
    s_cbranch_scc1 C_WH_D
    s_and_b64 exec, exec, vcc
    s_cbranch_execz C_WH_D
    s_sleep 2
    s_branch C_WH_P
C_WH_D:
    s_mov_b64 exec, -1

    s_mov_b32 s81, 0
SY16:
    ds_read_b32 v167, v165 offset:124
    s_add_u32 s81, s81, 1
    s_cmp_gt_u32 s81, 0x400000
    s_cbranch_scc1 SY16_D
    s_waitcnt lgkmcnt(0)
    v_readfirstlane_b32 s80, v167
    s_cmp_ge_u32 s80, 2
    s_cbranch_scc1 SY16_D
    s_sleep 1
    s_branch SY16
SY16_D:
    v_readlane_b32 s21, v16, 36
    v_and_b32 v11, 15, v1
    v_lshlrev_b32 v10, 4, v11
    ds_read_b32 v24, v10 offset:40516
    v_mul_u32_u24 v11, 80, v11
    v_lshlrev_b32 v8, 5, v1
    v_add_u32 v8, 40768, v8
    s_mov_b32 s57, 0xf
    s_mov_b64 exec, s[56:57]

    ds_write2_b32 v8, v16, v20 offset0:0 offset1:1
    ds_write2_b32 v8, v17, v21 offset0:2 offset1:3
    ds_write2_b32 v8, v18, v22 offset0:4 offset1:5
    ds_write2_b32 v8, v19, v23 offset0:6 offset1:7
    s_mov_b64 exec, -1
    s_waitcnt lgkmcnt(4)
    v_mul_f32 v24, s21, v24
    ds_write_b32 v11, v24 offset:39308

    s_waitcnt lgkmcnt(0)
    s_mov_b64 exec, 1
    ds_add_u32 v165, v166 offset:88
    s_mov_b64 exec, -1
C_TAB:

    s_bfe_u32 s22, s2, 0x10003
    s_sub_u32 s62, s20, 4
    s_cmp_lt_u32 s62, 5
    s_cselect_b32 s21, s62, s20
    s_cselect_b32 s23, 1, 0
    s_xor_b32 s22, s22, s23
    s_min_u32 s21, s21, 4
    s_lshl_b32 s21, s21, 4
    s_add_u32 s21, s21, s22
    v_and_b32 v11, 15, v1
    v_lshl_add_u32 v12, v11, 1, s21
    s_sub_u32 s22, 114, s21
    v_lshl_add_u32 v13, v11, 1, s22
    v_cmp_gt_u32 vcc, 8, v11
    v_cndmask_b32 v12, v13, v12, vcc

    v_cvt_f32_u32 v16, v12
    v_mul_u32_u24 v17, 36, v9
    v_cvt_f32_u32 v17, v17
    v_mul_f32 v17, v17, v16
    v_mul_f32 v18, 0x3b638e39, v16

    v_mul_f32 v21, 0x3b638e39, v17
    v_floor_f32 v21, v21
    v_fmac_f32 v17, 0xc3900000, v21
    v_mul_f32 v20, 0x3b638e39, v17
    v_add_f32 v21, v20, v18
    v_fma_f32 v22, 2.0, v18, v20
    v_add_f32 v23, v22, v18
    v_add_f32 v28, v18, v18
    v_cos_f32 v28, v28
    v_mul_f32 v18, 0x3f000000, v18

    v_add_f32 v24, v20, v18
    v_add_f32 v25, v21, v18
    v_add_f32 v26, v22, v18
    v_add_f32 v27, v23, v18
    v_cos_f32 v32, v20
    v_cos_f32 v33, v21
    v_cos_f32 v34, v22
    v_cos_f32 v35, v23
    v_cos_f32 v36, v24
    v_cos_f32 v37, v25
    v_cos_f32 v38, v26
    v_cos_f32 v39, v27
    v_sin_f32 v40, v20
    v_sin_f32 v41, v21
    v_sin_f32 v42, v22
    v_sin_f32 v43, v23
    v_add_f32 v28, v28, v28
    v_and_b32 v29, 1, v12
    v_lshlrev_b32 v29, 15, v29
    v_cmp_eq_u32 vcc, 0, v9
    v_cndmask_b32 v29, 0, v29, vcc

    v_cvt_pk_bf16_f32 v104, v32, v33
    v_cvt_pk_bf16_f32 v108, v36, v37
    v_cvt_pk_bf16_f32 v112, v40, v41
    v_pk_fma_f32 v[32:33], v[34:35], v[28:29], v[32:33] op_sel_hi:[1,0,1] neg_lo:[0,0,1] neg_hi:[0,0,1]
    v_cvt_pk_bf16_f32 v105, v34, v35
    v_pk_fma_f32 v[36:37], v[38:39], v[28:29], v[36:37] op_sel_hi:[1,0,1] neg_lo:[0,0,1] neg_hi:[0,0,1]
    v_cvt_pk_bf16_f32 v109, v38, v39
    v_pk_fma_f32 v[40:41], v[42:43], v[28:29], v[40:41] op_sel_hi:[1,0,1] neg_lo:[0,0,1] neg_hi:[0,0,1]
    v_cvt_pk_bf16_f32 v113, v42, v43
    v_pk_fma_f32 v[34:35], v[32:33], v[28:29], v[34:35] op_sel_hi:[1,0,1] neg_lo:[0,0,1] neg_hi:[0,0,1]
    v_cvt_pk_bf16_f32 v106, v32, v33
    v_pk_fma_f32 v[38:39], v[36:37], v[28:29], v[38:39] op_sel_hi:[1,0,1] neg_lo:[0,0,1] neg_hi:[0,0,1]
    v_cvt_pk_bf16_f32 v110, v36, v37
    v_pk_fma_f32 v[42:43], v[40:41], v[28:29], v[42:43] op_sel_hi:[1,0,1] neg_lo:[0,0,1] neg_hi:[0,0,1]
    v_cvt_pk_bf16_f32 v114, v40, v41
    v_pk_fma_f32 v[32:33], v[34:35], v[28:29], v[32:33] op_sel_hi:[1,0,1] neg_lo:[0,0,1] neg_hi:[0,0,1]
    v_cvt_pk_bf16_f32 v107, v34, v35
    v_pk_fma_f32 v[36:37], v[38:39], v[28:29], v[36:37] op_sel_hi:[1,0,1] neg_lo:[0,0,1] neg_hi:[0,0,1]
    v_cvt_pk_bf16_f32 v111, v38, v39
    v_pk_fma_f32 v[40:41], v[42:43], v[28:29], v[40:41] op_sel_hi:[1,0,1] neg_lo:[0,0,1] neg_hi:[0,0,1]
    v_cvt_pk_bf16_f32 v115, v42, v43
    v_pk_fma_f32 v[34:35], v[32:33], v[28:29], v[34:35] op_sel_hi:[1,0,1] neg_lo:[0,0,1] neg_hi:[0,0,1]
    v_cvt_pk_bf16_f32 v116, v32, v33
    v_pk_fma_f32 v[38:39], v[36:37], v[28:29], v[38:39] op_sel_hi:[1,0,1] neg_lo:[0,0,1] neg_hi:[0,0,1]
    v_cvt_pk_bf16_f32 v120, v36, v37
    v_pk_fma_f32 v[42:43], v[40:41], v[28:29], v[42:43] op_sel_hi:[1,0,1] neg_lo:[0,0,1] neg_hi:[0,0,1]
    v_cvt_pk_bf16_f32 v124, v40, v41
    v_pk_fma_f32 v[32:33], v[34:35], v[28:29], v[32:33] op_sel_hi:[1,0,1] neg_lo:[0,0,1] neg_hi:[0,0,1]
    v_cvt_pk_bf16_f32 v117, v34, v35
    v_pk_fma_f32 v[36:37], v[38:39], v[28:29], v[36:37] op_sel_hi:[1,0,1] neg_lo:[0,0,1] neg_hi:[0,0,1]
    v_cvt_pk_bf16_f32 v121, v38, v39
    v_pk_fma_f32 v[40:41], v[42:43], v[28:29], v[40:41] op_sel_hi:[1,0,1] neg_lo:[0,0,1] neg_hi:[0,0,1]
    v_cvt_pk_bf16_f32 v125, v42, v43
    v_pk_fma_f32 v[34:35], v[32:33], v[28:29], v[34:35] op_sel_hi:[1,0,1] neg_lo:[0,0,1] neg_hi:[0,0,1]
    v_cvt_pk_bf16_f32 v118, v32, v33
    v_pk_fma_f32 v[38:39], v[36:37], v[28:29], v[38:39] op_sel_hi:[1,0,1] neg_lo:[0,0,1] neg_hi:[0,0,1]
    v_cvt_pk_bf16_f32 v122, v36, v37
    v_pk_fma_f32 v[42:43], v[40:41], v[28:29], v[42:43] op_sel_hi:[1,0,1] neg_lo:[0,0,1] neg_hi:[0,0,1]
    v_cvt_pk_bf16_f32 v126, v40, v41
    v_pk_fma_f32 v[32:33], v[34:35], v[28:29], v[32:33] op_sel_hi:[1,0,1] neg_lo:[0,0,1] neg_hi:[0,0,1]
    v_cvt_pk_bf16_f32 v119, v34, v35
    v_pk_fma_f32 v[36:37], v[38:39], v[28:29], v[36:37] op_sel_hi:[1,0,1] neg_lo:[0,0,1] neg_hi:[0,0,1]
    v_cvt_pk_bf16_f32 v123, v38, v39
    v_pk_fma_f32 v[40:41], v[42:43], v[28:29], v[40:41] op_sel_hi:[1,0,1] neg_lo:[0,0,1] neg_hi:[0,0,1]
    v_cvt_pk_bf16_f32 v127, v42, v43
    v_pk_fma_f32 v[34:35], v[32:33], v[28:29], v[34:35] op_sel_hi:[1,0,1] neg_lo:[0,0,1] neg_hi:[0,0,1]
    v_cvt_pk_bf16_f32 v128, v32, v33
    v_pk_fma_f32 v[38:39], v[36:37], v[28:29], v[38:39] op_sel_hi:[1,0,1] neg_lo:[0,0,1] neg_hi:[0,0,1]
    v_cvt_pk_bf16_f32 v132, v36, v37
    v_pk_fma_f32 v[42:43], v[40:41], v[28:29], v[42:43] op_sel_hi:[1,0,1] neg_lo:[0,0,1] neg_hi:[0,0,1]
    v_cvt_pk_bf16_f32 v136, v40, v41
    v_pk_fma_f32 v[32:33], v[34:35], v[28:29], v[32:33] op_sel_hi:[1,0,1] neg_lo:[0,0,1] neg_hi:[0,0,1]
    v_cvt_pk_bf16_f32 v129, v34, v35
    v_pk_fma_f32 v[36:37], v[38:39], v[28:29], v[36:37] op_sel_hi:[1,0,1] neg_lo:[0,0,1] neg_hi:[0,0,1]
    v_cvt_pk_bf16_f32 v133, v38, v39
    v_pk_fma_f32 v[40:41], v[42:43], v[28:29], v[40:41] op_sel_hi:[1,0,1] neg_lo:[0,0,1] neg_hi:[0,0,1]
    v_cvt_pk_bf16_f32 v137, v42, v43
    v_pk_fma_f32 v[34:35], v[32:33], v[28:29], v[34:35] op_sel_hi:[1,0,1] neg_lo:[0,0,1] neg_hi:[0,0,1]
    v_cvt_pk_bf16_f32 v130, v32, v33
    v_pk_fma_f32 v[38:39], v[36:37], v[28:29], v[38:39] op_sel_hi:[1,0,1] neg_lo:[0,0,1] neg_hi:[0,0,1]
    v_cvt_pk_bf16_f32 v134, v36, v37
    v_pk_fma_f32 v[42:43], v[40:41], v[28:29], v[42:43] op_sel_hi:[1,0,1] neg_lo:[0,0,1] neg_hi:[0,0,1]
    v_cvt_pk_bf16_f32 v138, v40, v41
    v_pk_fma_f32 v[32:33], v[34:35], v[28:29], v[32:33] op_sel_hi:[1,0,1] neg_lo:[0,0,1] neg_hi:[0,0,1]
    v_cvt_pk_bf16_f32 v131, v34, v35
    v_pk_fma_f32 v[36:37], v[38:39], v[28:29], v[36:37] op_sel_hi:[1,0,1] neg_lo:[0,0,1] neg_hi:[0,0,1]
    v_cvt_pk_bf16_f32 v135, v38, v39
    v_pk_fma_f32 v[40:41], v[42:43], v[28:29], v[40:41] op_sel_hi:[1,0,1] neg_lo:[0,0,1] neg_hi:[0,0,1]
    v_cvt_pk_bf16_f32 v139, v42, v43
    v_pk_fma_f32 v[34:35], v[32:33], v[28:29], v[34:35] op_sel_hi:[1,0,1] neg_lo:[0,0,1] neg_hi:[0,0,1]
    v_cvt_pk_bf16_f32 v140, v32, v33
    v_pk_fma_f32 v[38:39], v[36:37], v[28:29], v[38:39] op_sel_hi:[1,0,1] neg_lo:[0,0,1] neg_hi:[0,0,1]
    v_cvt_pk_bf16_f32 v144, v36, v37
    v_pk_fma_f32 v[42:43], v[40:41], v[28:29], v[42:43] op_sel_hi:[1,0,1] neg_lo:[0,0,1] neg_hi:[0,0,1]
    v_cvt_pk_bf16_f32 v148, v40, v41
    v_pk_fma_f32 v[32:33], v[34:35], v[28:29], v[32:33] op_sel_hi:[1,0,1] neg_lo:[0,0,1] neg_hi:[0,0,1]
    v_cvt_pk_bf16_f32 v141, v34, v35
    v_pk_fma_f32 v[36:37], v[38:39], v[28:29], v[36:37] op_sel_hi:[1,0,1] neg_lo:[0,0,1] neg_hi:[0,0,1]
    v_cvt_pk_bf16_f32 v145, v38, v39
    v_pk_fma_f32 v[40:41], v[42:43], v[28:29], v[40:41] op_sel_hi:[1,0,1] neg_lo:[0,0,1] neg_hi:[0,0,1]
    v_cvt_pk_bf16_f32 v149, v42, v43
    v_pk_fma_f32 v[34:35], v[32:33], v[28:29], v[34:35] op_sel_hi:[1,0,1] neg_lo:[0,0,1] neg_hi:[0,0,1]
    v_cvt_pk_bf16_f32 v142, v32, v33
    v_pk_fma_f32 v[38:39], v[36:37], v[28:29], v[38:39] op_sel_hi:[1,0,1] neg_lo:[0,0,1] neg_hi:[0,0,1]
    v_cvt_pk_bf16_f32 v146, v36, v37
    v_pk_fma_f32 v[42:43], v[40:41], v[28:29], v[42:43] op_sel_hi:[1,0,1] neg_lo:[0,0,1] neg_hi:[0,0,1]
    v_cvt_pk_bf16_f32 v150, v40, v41
    v_pk_fma_f32 v[32:33], v[34:35], v[28:29], v[32:33] op_sel_hi:[1,0,1] neg_lo:[0,0,1] neg_hi:[0,0,1]
    v_cvt_pk_bf16_f32 v143, v34, v35
    v_pk_fma_f32 v[36:37], v[38:39], v[28:29], v[36:37] op_sel_hi:[1,0,1] neg_lo:[0,0,1] neg_hi:[0,0,1]
    v_cvt_pk_bf16_f32 v147, v38, v39
    v_pk_fma_f32 v[40:41], v[42:43], v[28:29], v[40:41] op_sel_hi:[1,0,1] neg_lo:[0,0,1] neg_hi:[0,0,1]
    v_cvt_pk_bf16_f32 v151, v42, v43
    v_pk_fma_f32 v[34:35], v[32:33], v[28:29], v[34:35] op_sel_hi:[1,0,1] neg_lo:[0,0,1] neg_hi:[0,0,1]
    v_cvt_pk_bf16_f32 v152, v32, v33
    v_pk_fma_f32 v[38:39], v[36:37], v[28:29], v[38:39] op_sel_hi:[1,0,1] neg_lo:[0,0,1] neg_hi:[0,0,1]
    v_cvt_pk_bf16_f32 v156, v36, v37
    v_pk_fma_f32 v[42:43], v[40:41], v[28:29], v[42:43] op_sel_hi:[1,0,1] neg_lo:[0,0,1] neg_hi:[0,0,1]
    v_cvt_pk_bf16_f32 v160, v40, v41
    v_cvt_pk_bf16_f32 v153, v34, v35
    v_cvt_pk_bf16_f32 v157, v38, v39
    v_cvt_pk_bf16_f32 v161, v42, v43
    v_xor_b32 v104, v29, v104
    v_lshrrev_b32 v9, 2, v0
    v_and_b32 v11, 3, v0
    v_lshlrev_b32 v8, 4, v11
    v_lshlrev_b32 v10, 3, v9
    v_mov_b32 v46, 0x05040100
    v_mov_b32 v47, 0x07060302
    v_mov_b32 v13, 0x01000100
    v_mov_b32 v14, 0x03020302
    v_cmp_eq_u32 vcc, 0, v9
    v_cndmask_b32 v46, v46, v13, vcc
    v_cndmask_b32 v47, v47, v14, vcc
    v_mov_b32 v13, 0x3e800000
    v_cndmask_b32 v87, 0.5, v13, vcc
    v_lshlrev_b32 v86, 31, v9
    v_mul_u32_u24 v13, 57, v9
    v_lshrrev_b32 v13, 11, v13
    v_lshl_add_u32 v103, v13, 3, v2
    v_add_u32 v15, 10272, v103
    v_mul_u32_u24 v11, 320, v11
    v_bfe_u32 v13, v1, 4, 1
    v_mul_u32_u24 v13, 80, v13
    v_lshrrev_b32 v14, 5, v1
    v_lshl_add_u32 v13, v14, 2, v13
    s_lshl_b32 s21, s20, 3
    s_add_u32 s21, s21, 39232
    v_add3_u32 v102, v11, v13, s21
    v_mul_u32_u24 v11, 1168, v4
    v_add_u32 v11, v11, v3
    v_add_u32 v11, 116544, v11
    s_mov_b32 s58, 0x05040100
    s_mov_b32 s59, 0x07060302
    v_lshrrev_b32 v9, 4, v1

    v_and_b32 v13, 15, v1
    v_lshlrev_b32 v99, 4, v4
    v_lshlrev_b32 v14, 4, v13
    v_mul_u32_u24 v13, 4672, v9
    v_add_u32 v13, 20544, v13
    v_lshlrev_b32 v12, 1, v12
    v_add_u32 v97, v13, v12
    v_sub_u32 v98, v13, v12
    v_add_u32 v7, 20544, v7
    v_mov_b32 v164, v165
    s_mov_b32 s56, 0x3f80
    s_mov_b32 s57, 0x3f800000
    s_mov_b32 s62, 0
    s_mov_b64 s[60:61], 0
    s_mov_b32 s54, 7

    s_add_u32 s40, s30, 0x1410000
    s_addc_u32 s41, s31, 0
    s_mov_b32 s42, 0xb440
    s_mov_b32 s43, 0x00020000
    s_cmp_eq_u32 s20, 9
    s_cbranch_scc1 C_K9

    ds_read2_b32 v[24:25], v11 offset0:0 offset1:1
    ds_read_b32 v26, v11 offset:8
    ds_read2_b32 v[28:29], v11 offset0:96 offset1:97
    ds_read_b32 v30, v11 offset:392
    ds_read2_b32 v[32:33], v11 offset0:192 offset1:193
    ds_read_b32 v34, v11 offset:776
    s_waitcnt lgkmcnt(0)
    v_lshlrev_b32 v88, 16, v24
    v_and_b32 v24, 0xffff0000, v24
    v_lshlrev_b32 v89, 16, v25
    v_and_b32 v25, 0xffff0000, v25
    v_lshlrev_b32 v90, 16, v26
    v_and_b32 v26, 0xffff0000, v26
    v_lshlrev_b32 v91, 16, v28
    v_and_b32 v28, 0xffff0000, v28
    v_lshlrev_b32 v92, 16, v29
    v_and_b32 v29, 0xffff0000, v29
    v_lshlrev_b32 v93, 16, v30
    v_and_b32 v30, 0xffff0000, v30
    v_lshlrev_b32 v94, 16, v32
    v_and_b32 v32, 0xffff0000, v32
    v_lshlrev_b32 v95, 16, v33
    v_and_b32 v33, 0xffff0000, v33
    v_lshlrev_b32 v96, 16, v34
    v_and_b32 v34, 0xffff0000, v34
    s_mov_b32 s63, 0
    s_cmp_lt_u32 s20, 4
    s_cbranch_scc1 C_ZP_C

    s_mov_b32 s81, 0
SY17:
    ds_read_b32 v167, v165 offset:104
    s_add_u32 s81, s81, 1
    s_cmp_gt_u32 s81, 0x400000
    s_cbranch_scc1 SY17_D
    s_waitcnt lgkmcnt(0)
    v_readfirstlane_b32 s80, v167
    s_cmp_ge_u32 s80, 1
    s_cbranch_scc1 SY17_D
    s_sleep 2
    s_branch SY17
SY17_D:
    s_mov_b32 s63, 0
C_ZP_P:
    buffer_load_dwordx4 v[56:59], v101, s[4:7], s16 offen sc0 sc1
    buffer_load_dwordx4 v[60:63], v101, s[4:7], s17 offen sc0 sc1
C_ZP_C:
    s_waitcnt vmcnt(0)
    v_max_u32 v13, v56, v60
    v_cmp_eq_u32 vcc, -1, v13
    s_add_u32 s63, s63, 1
    s_cmp_gt_u32 s63, 200000
    s_cbranch_scc1 C_ZP_D
    s_and_b64 exec, exec, vcc
    s_cbranch_execz C_ZP_D
    s_sleep 2
    s_branch C_ZP_P
C_ZP_D:
    s_mov_b64 exec, -1

    s_mov_b32 s81, 0
SY18:
    ds_read_b32 v167, v165 offset:88
    s_add_u32 s81, s81, 1
    s_cmp_gt_u32 s81, 0x400000
    s_cbranch_scc1 SY18_D
    s_waitcnt lgkmcnt(0)
    v_readfirstlane_b32 s80, v167
    s_cmp_ge_u32 s80, 1
    s_cbranch_scc1 SY18_D
    s_sleep 2
    s_branch SY18
SY18_D:
    ds_read_b128 v[80:83], v8 offset:42048
    ds_read_b64 v[44:45], v10 offset:40768
    v_mov_b32 v10, v100
    s_waitcnt lgkmcnt(0)
    v_lshlrev_b32 v64, 16, v56
    v_lshlrev_b32 v65, 16, v58
    v_pk_mul_f32 v[64:65], v[64:65], v[80:81] op_sel_hi:[1,0]
    v_cvt_pk_bf16_f32 v36, v64, v65
    v_and_b32 v66, 0xffff0000, v56
    v_and_b32 v67, 0xffff0000, v58
    v_mul_f32 v66, v66, v81
    v_mul_f32 v67, v67, v81
    v_cvt_pk_bf16_f32 v37, v66, v67
    v_lshlrev_b32 v64, 16, v57
    v_lshlrev_b32 v65, 16, v59
    v_pk_mul_f32 v[64:65], v[64:65], v[82:83] op_sel_hi:[1,0]
    v_cvt_pk_bf16_f32 v38, v64, v65
    v_and_b32 v66, 0xffff0000, v57
    v_and_b32 v67, 0xffff0000, v59
    v_mul_f32 v66, v66, v83
    v_mul_f32 v67, v67, v83
    v_cvt_pk_bf16_f32 v39, v66, v67
    v_lshlrev_b32 v64, 16, v60
    v_lshlrev_b32 v65, 16, v62
    v_pk_mul_f32 v[64:65], v[64:65], v[80:81] op_sel_hi:[1,0]
    v_cvt_pk_bf16_f32 v40, v64, v65
    v_xor_b32 v40, v86, v40
    v_and_b32 v66, 0xffff0000, v60
    v_and_b32 v67, 0xffff0000, v62
    v_mul_f32 v66, v66, v81
    v_mul_f32 v67, v67, v81
    v_cvt_pk_bf16_f32 v41, v66, v67
    v_xor_b32 v41, v86, v41
    v_lshlrev_b32 v64, 16, v61
    v_lshlrev_b32 v65, 16, v63
    v_pk_mul_f32 v[64:65], v[64:65], v[82:83] op_sel_hi:[1,0]
    v_cvt_pk_bf16_f32 v42, v64, v65
    v_xor_b32 v42, v86, v42
    v_and_b32 v66, 0xffff0000, v61
    v_and_b32 v67, 0xffff0000, v63
    v_mul_f32 v66, v66, v83
    v_mul_f32 v67, v67, v83
    v_cvt_pk_bf16_f32 v43, v66, v67
    v_xor_b32 v43, v86, v43
    v_dot2_f32_bf16 v64, v36, v44, 0
    v_dot2_f32_bf16 v68, v40, v45, 0
    v_dot2_f32_bf16 v65, v37, v44, 0
    v_dot2_f32_bf16 v69, v41, v45, 0
    v_dot2_f32_bf16 v66, v38, v44, 0
    v_dot2_f32_bf16 v70, v42, v45, 0
    v_dot2_f32_bf16 v67, v39, v44, 0
    v_dot2_f32_bf16 v71, v43, v45, 0
    s_nop 2
    v_mul_f32 v64, v87, v64
    v_fma_f32 v49, 0.5, v68, v64
    v_mul_f32 v65, v87, v65
    v_fma_f32 v51, 0.5, v69, v65
    v_mul_f32 v66, v87, v66
    v_fma_f32 v53, 0.5, v70, v66
    v_mul_f32 v67, v87, v67
    v_fma_f32 v55, 0.5, v71, v67
    s_mov_b32 s81, 0
SY19:
    ds_read_b32 v167, v165 offset:28
    s_add_u32 s81, s81, 1
    s_cmp_gt_u32 s81, 0x400000
    s_cbranch_scc1 SY19_D
    s_waitcnt lgkmcnt(0)
    v_readfirstlane_b32 s80, v167
    s_cmp_ge_u32 s80, 4
    s_cbranch_scc1 SY19_D
    s_sleep 2
    s_branch SY19
SY19_D:
    s_mov_b32 s63, 0
KF_T_P:
    buffer_load_dwordx4 v[16:19], v101, s[12:15], s16 offen sc0 sc1
    buffer_load_dwordx4 v[20:23], v101, s[12:15], s17 offen sc0 sc1
KF_T_C:
    s_waitcnt vmcnt(0)
    v_or_b32 v8, v16, v20
    v_and_b32 v8, 1, v8
    v_cmp_eq_u32 vcc, 1, v8
    s_add_u32 s63, s63, 1
    s_cmp_gt_u32 s63, 200000
    s_cbranch_scc1 KF_T_D
    s_and_b64 exec, exec, vcc
    s_cbranch_execz KF_T_D
    s_nop 0
    s_branch KF_T_P
KF_T_D:
    s_mov_b64 exec, -1

    ds_write2_b64 v103, v[16:17], v[18:19] offset0:0 offset1:1
    ds_write2_b64 v15, v[20:21], v[22:23] offset0:0 offset1:1
    v_perm_b32 v64, v18, v16, v46
    v_perm_b32 v65, v18, v16, v47
    v_perm_b32 v66, v19, v17, v46
    v_perm_b32 v67, v19, v17, v47
    v_perm_b32 v68, v22, v20, s58
    v_perm_b32 v69, v22, v20, s59
    v_perm_b32 v70, v23, v21, s58
    v_perm_b32 v71, v23, v21, s59
    v_dot2_f32_bf16 v48, v64, v64, 0
    v_dot2_f32_bf16 v49, v64, v44, v49
    v_dot2_f32_bf16 v48, v64, v36, v48
    v_dot2_f32_bf16 v50, v65, v65, 0
    v_dot2_f32_bf16 v51, v65, v44, v51
    v_dot2_f32_bf16 v50, v65, v37, v50
    v_dot2_f32_bf16 v52, v66, v66, 0
    v_dot2_f32_bf16 v53, v66, v44, v53
    v_dot2_f32_bf16 v52, v66, v38, v52
    v_dot2_f32_bf16 v54, v67, v67, 0
    v_dot2_f32_bf16 v55, v67, v44, v55
    v_dot2_f32_bf16 v54, v67, v39, v54
    v_dot2_f32_bf16 v48, v68, v68, v48
    v_dot2_f32_bf16 v49, v68, v45, v49
    v_dot2_f32_bf16 v48, v68, v40, v48
    v_dot2_f32_bf16 v50, v69, v69, v50
    v_dot2_f32_bf16 v51, v69, v45, v51
    v_dot2_f32_bf16 v50, v69, v41, v50
    v_dot2_f32_bf16 v52, v70, v70, v52
    v_dot2_f32_bf16 v53, v70, v45, v53
    v_dot2_f32_bf16 v52, v70, v42, v52
    v_dot2_f32_bf16 v54, v71, v71, v54
    v_dot2_f32_bf16 v55, v71, v45, v55
    v_dot2_f32_bf16 v54, v71, v43, v54
    v_permlane32_swap_b32 v48, v49
    v_permlane32_swap_b32 v50, v51
    v_permlane32_swap_b32 v52, v53
    s_nop 0
    v_permlane32_swap_b32 v54, v55
    v_add_f32 v56, v48, v49
    v_add_f32 v57, v50, v51
    v_add_f32 v58, v52, v53
    v_add_f32 v59, v54, v55
    s_mov_b32 s18, 0x000f000f
    v_permlane16_swap_b32 v56, v57
    v_permlane16_swap_b32 v58, v59
    s_mov_b32 s19, s18
    v_add_f32 v56, v56, v57
    v_add_f32 v58, v58, v59
    s_nop 0
    v_add_f32_dpp v48, v56, v56 row_ror:8 row_mask:0xf bank_mask:0xf
    v_add_f32_dpp v49, v58, v58 row_ror:8 row_mask:0xf bank_mask:0xf
    s_nop 0
    v_add_f32_dpp v50, v48, v48 row_ror:4 row_mask:0xf bank_mask:0xf
    v_add_f32_dpp v51, v49, v49 row_ror:4 row_mask:0xf bank_mask:0xf
    s_mov_b64 exec, s[18:19]
    ds_write2_b32 v102, v50, v51 offset0:0 offset1:40
    s_mov_b64 exec, -1

    s_waitcnt lgkmcnt(0)
    s_setprio 2
    s_barrier
    s_branch C_MM
C_K9:
    v_mov_b32 v16, 0
    v_mov_b32 v17, 0
    v_mov_b32 v10, v100

    v_and_b32 v11, 15, v1
    v_mul_u32_u24 v8, 80, v11
    v_lshlrev_b32 v19, 2, v11
    v_lshl_add_u32 v19, v9, 13, v19
    s_lshl_b32 s21, s2, 6
    s_lshl_b32 s22, s2, 4
    s_sub_u32 s22, 0x7ff, s22
    v_sub_u32 v18, s22, v11
    v_lshlrev_b32 v11, 4, v11
    s_mov_b32 s23, 0xffff0000
    s_setprio 3
    s_waitcnt lgkmcnt(0)
    s_barrier

    ds_read_b128 v[64:67], v8 offset:39232
    ds_read_b128 v[68:71], v8 offset:39248
    ds_read_b128 v[72:75], v8 offset:39264
    ds_read_b128 v[76:79], v8 offset:39280
    ds_read_b128 v[80:83], v8 offset:39296
    s_waitcnt lgkmcnt(4)
    v_pk_add_f32 v[64:65], v[64:65], v[66:67]
    s_waitcnt lgkmcnt(3)
    v_pk_add_f32 v[68:69], v[68:69], v[70:71]
    v_pk_add_f32 v[64:65], v[64:65], v[68:69]
    s_waitcnt lgkmcnt(2)
    v_pk_add_f32 v[72:73], v[72:73], v[74:75]
    s_waitcnt lgkmcnt(1)
    v_pk_add_f32 v[76:77], v[76:77], v[78:79]
    v_pk_add_f32 v[72:73], v[72:73], v[76:77]
    v_pk_add_f32 v[64:65], v[64:65], v[72:73]
    s_waitcnt lgkmcnt(0)
    v_pk_add_f32 v[80:81], v[80:81], v[82:83]
    v_pk_add_f32 v[64:65], v[64:65], v[80:81]
    v_mul_f32 v64, 0.5, v64

    v_cvt_pk_bf16_f32 v64, v64, v64
    v_lshlrev_b32 v64, 16, v64
    v_add_f32 v64, 0x3727c5ac, v64
    v_cvt_pk_bf16_f32 v64, v64, v64
    v_lshlrev_b32 v64, 16, v64
    v_sqrt_f32 v64, v64
    s_nop 0
    v_cvt_pk_bf16_f32 v64, v64, v64
    v_lshlrev_b32 v64, 16, v64
    v_rcp_f32 v16, v64
    s_nop 0
    v_mul_f32 v17, v65, v16
    v_cvt_pk_bf16_f32 v17, v17, v17
    v_ashrrev_i32 v20, 31, v17
    v_or_b32 v20, 0x80000000, v20
    v_xor_b32 v17, v17, v20
    v_and_or_b32 v17, v17, s23, v18
    buffer_store_dword v17, v19, s[48:51], s21 offen sc0 sc1
    ds_write_b64 v11, v[16:17] offset:40520
    s_setprio 2

    s_mov_b64 exec, 1
    ds_add_u32 v165, v166 offset:44
    s_mov_b64 exec, -1
C_MM:
    ds_read_b64_tr_b16 v[64:65], v10 offset:0
    ds_read_b64_tr_b16 v[66:67], v10 offset:256
    ds_read_b64_tr_b16 v[68:69], v10 offset:8
    ds_read_b64_tr_b16 v[70:71], v10 offset:264
    ds_read_b64_tr_b16 v[72:73], v10 offset:10272
    ds_read_b64_tr_b16 v[74:75], v10 offset:10528
    ds_read_b64_tr_b16 v[76:77], v10 offset:10280
    ds_read_b64_tr_b16 v[78:79], v10 offset:10536
    ds_read_b64_tr_b16 v[80:81], v10 offset:512
    ds_read_b64_tr_b16 v[82:83], v10 offset:768
    ds_read_b64_tr_b16 v[84:85], v10 offset:520
    ds_read_b64_tr_b16 v[86:87], v10 offset:776
    s_waitcnt lgkmcnt(10)
    v_mfma_f32_16x16x32_bf16 v[48:51], v[64:67], v[104:107], 0
    ds_read_b64_tr_b16 v[64:65], v10 offset:10784
    ds_read_b64_tr_b16 v[66:67], v10 offset:11040
    s_waitcnt lgkmcnt(10)
    v_mfma_f32_16x16x32_bf16 v[56:59], v[68:71], v[112:115], 0
    ds_read_b64_tr_b16 v[68:69], v10 offset:10792
    ds_read_b64_tr_b16 v[70:71], v10 offset:11048
    s_waitcnt lgkmcnt(10)
    v_mfma_f32_16x16x32_bf16 v[52:55], v[72:75], v[108:111], 0
    ds_read_b64_tr_b16 v[72:73], v10 offset:1024
    ds_read_b64_tr_b16 v[74:75], v10 offset:1280
    s_waitcnt lgkmcnt(10)
    v_mfma_f32_16x16x32_bf16 v[60:63], v[76:79], v[108:111], 0
    ds_read_b64_tr_b16 v[76:77], v10 offset:1032
    ds_read_b64_tr_b16 v[78:79], v10 offset:1288
    s_waitcnt lgkmcnt(10)
    v_mfma_f32_16x16x32_bf16 v[48:51], v[80:83], v[116:119], v[48:51]
    ds_read_b64_tr_b16 v[80:81], v10 offset:11296
    ds_read_b64_tr_b16 v[82:83], v10 offset:11552
    s_waitcnt lgkmcnt(10)
    v_mfma_f32_16x16x32_bf16 v[56:59], v[84:87], v[124:127], v[56:59]
    ds_read_b64_tr_b16 v[84:85], v10 offset:11304
    ds_read_b64_tr_b16 v[86:87], v10 offset:11560
    s_waitcnt lgkmcnt(10)
    v_mfma_f32_16x16x32_bf16 v[52:55], v[64:67], v[120:123], v[52:55]
    ds_read_b64_tr_b16 v[64:65], v10 offset:1536
    ds_read_b64_tr_b16 v[66:67], v10 offset:1792
    s_waitcnt lgkmcnt(10)
    v_mfma_f32_16x16x32_bf16 v[60:63], v[68:71], v[120:123], v[60:63]
    ds_read_b64_tr_b16 v[68:69], v10 offset:1544
    ds_read_b64_tr_b16 v[70:71], v10 offset:1800
    s_waitcnt lgkmcnt(10)
    v_mfma_f32_16x16x32_bf16 v[48:51], v[72:75], v[128:131], v[48:51]
    ds_read_b64_tr_b16 v[72:73], v10 offset:11808
    ds_read_b64_tr_b16 v[74:75], v10 offset:12064
    s_waitcnt lgkmcnt(10)
    v_mfma_f32_16x16x32_bf16 v[56:59], v[76:79], v[136:139], v[56:59]
    ds_read_b64_tr_b16 v[76:77], v10 offset:11816
    ds_read_b64_tr_b16 v[78:79], v10 offset:12072
    s_waitcnt lgkmcnt(10)
    v_mfma_f32_16x16x32_bf16 v[52:55], v[80:83], v[132:135], v[52:55]
    ds_read_b64_tr_b16 v[80:81], v10 offset:2048
    s_waitcnt lgkmcnt(9)
    v_mfma_f32_16x16x32_bf16 v[60:63], v[84:87], v[132:135], v[60:63]
    ds_read_b64_tr_b16 v[84:85], v10 offset:2056
    s_waitcnt lgkmcnt(8)
    v_mfma_f32_16x16x32_bf16 v[48:51], v[64:67], v[140:143], v[48:51]
    ds_read_b64_tr_b16 v[64:65], v10 offset:12320
    s_waitcnt lgkmcnt(7)
    v_mfma_f32_16x16x32_bf16 v[56:59], v[68:71], v[148:151], v[56:59]
    ds_read_b64_tr_b16 v[68:69], v10 offset:12328
    s_waitcnt lgkmcnt(6)
    v_mfma_f32_16x16x32_bf16 v[52:55], v[72:75], v[144:147], v[52:55]
    ds_read_b32 v167, v165 offset:44
    ds_read_b128 v[140:143], v99 offset:40512
    ds_read_b32 v15, v14 offset:40524

    s_waitcnt lgkmcnt(7)
    v_mfma_f32_16x16x32_bf16 v[60:63], v[76:79], v[144:147], v[60:63]
    s_waitcnt lgkmcnt(6)
    v_mfma_f32_16x16x16_bf16 v[48:51], v[80:81], v[152:153], v[48:51]
    s_waitcnt lgkmcnt(5)
    v_mfma_f32_16x16x16_bf16 v[56:59], v[84:85], v[160:161], v[56:59]
    s_waitcnt lgkmcnt(4)
    v_mfma_f32_16x16x16_bf16 v[52:55], v[64:65], v[156:157], v[52:55]
    s_waitcnt lgkmcnt(3)
    v_mfma_f32_16x16x16_bf16 v[60:63], v[68:69], v[156:157], v[60:63]
    s_setprio 0
    s_waitcnt lgkmcnt(0)
    v_readfirstlane_b32 s80, v167
    s_cmp_ge_u32 s80, 1
    s_cbranch_scc1 C_KOK

    s_mov_b32 s81, 0
SY20:
    ds_read_b32 v167, v165 offset:44
    s_add_u32 s81, s81, 1
    s_cmp_gt_u32 s81, 0x400000
    s_cbranch_scc1 SY20_D
    s_waitcnt lgkmcnt(0)
    v_readfirstlane_b32 s80, v167
    s_cmp_ge_u32 s80, 1
    s_cbranch_scc0 SY20
SY20_D:
    ds_read_b32 v167, v165 offset:44
    ds_read_b128 v[140:143], v99 offset:40512
    ds_read_b32 v15, v14 offset:40524

    s_waitcnt lgkmcnt(0)
C_KOK:

    v_readlane_b32 s52, v143, 0
    v_readlane_b32 s53, v143, 32
    v_xor_b32 v141, 0x80000000, v140
    s_nop 1
    v_cmp_lt_u32 s[32:33], s52, v15
    v_cmp_lt_u32 s[34:35], s53, v15
    s_bcnt1_i32_b32 s52, s32
    s_bcnt1_i32_b32 s53, s34
    s_lshr_b32 s52, s52, 1
    s_lshr_b32 s53, s53, 1
    s_min_u32 s55, s52, s53

    s_nop 2
    v_mov_b32_dpp v16, v60 row_mirror row_mask:0xf bank_mask:0xf
    v_mov_b32_dpp v17, v61 row_mirror row_mask:0xf bank_mask:0xf
    v_pk_add_f32 v[18:19], v[48:49], v[52:53]
    v_pk_add_f32 v[20:21], v[48:49], v[52:53] neg_lo:[0,1] neg_hi:[0,1]
    v_pk_add_f32 v[22:23], v[56:57], v[16:17]
    v_pk_add_f32 v[16:17], v[56:57], v[16:17] neg_lo:[0,1] neg_hi:[0,1]
    v_pk_add_f32 v[48:49], v[18:19], v[22:23] neg_lo:[0,1] neg_hi:[0,1]
    v_pk_add_f32 v[52:53], v[18:19], v[22:23]
    v_pk_add_f32 v[56:57], v[20:21], v[16:17]
    v_pk_add_f32 v[60:61], v[20:21], v[16:17] neg_lo:[0,1] neg_hi:[0,1]
    v_cvt_pk_bf16_f32 v64, v48, v52
    v_cvt_pk_bf16_f32 v65, v56, v60
    v_cvt_pk_bf16_f32 v66, v49, v53
    v_cvt_pk_bf16_f32 v67, v57, v61
    v_mov_b32_dpp v16, v62 row_mirror row_mask:0xf bank_mask:0xf
    v_mov_b32_dpp v17, v63 row_mirror row_mask:0xf bank_mask:0xf
    v_pk_add_f32 v[18:19], v[50:51], v[54:55]
    v_pk_add_f32 v[20:21], v[50:51], v[54:55] neg_lo:[0,1] neg_hi:[0,1]
    v_pk_add_f32 v[22:23], v[58:59], v[16:17]
    v_pk_add_f32 v[16:17], v[58:59], v[16:17] neg_lo:[0,1] neg_hi:[0,1]
    v_pk_add_f32 v[50:51], v[18:19], v[22:23] neg_lo:[0,1] neg_hi:[0,1]
    v_pk_add_f32 v[54:55], v[18:19], v[22:23]
    v_pk_add_f32 v[58:59], v[20:21], v[16:17]
    v_pk_add_f32 v[62:63], v[20:21], v[16:17] neg_lo:[0,1] neg_hi:[0,1]
    v_cvt_pk_bf16_f32 v68, v50, v54
    v_cvt_pk_bf16_f32 v69, v58, v62
    v_cvt_pk_bf16_f32 v70, v51, v55
    v_cvt_pk_bf16_f32 v71, v59, v63
    ds_write_b16 v97, v64 offset:0
    ds_write_b16_d16_hi v98, v64 offset:1152
    ds_write_b16 v98, v65 offset:576
    ds_write_b16_d16_hi v97, v65 offset:576
    ds_write_b16 v97, v66 offset:1168
    ds_write_b16_d16_hi v98, v66 offset:2320
    ds_write_b16 v98, v67 offset:1744
    ds_write_b16_d16_hi v97, v67 offset:1744
    ds_write_b16 v97, v68 offset:2336
    ds_write_b16_d16_hi v98, v68 offset:3488
    ds_write_b16 v98, v69 offset:2912
    ds_write_b16_d16_hi v97, v69 offset:2912
    ds_write_b16 v97, v70 offset:3504
    ds_write_b16_d16_hi v98, v70 offset:4656
    ds_write_b16 v98, v71 offset:4080
    ds_write_b16_d16_hi v97, v71 offset:4080
    s_cmp_ge_u32 s20, 8
    s_cbranch_scc1 C_RK
    s_cmp_ge_u32 s55, 2
    s_cbranch_scc1 C_NP
    s_setprio 3
C_NP:
    s_waitcnt lgkmcnt(0)

    s_barrier
    ds_read2_b32 v[104:105], v7 offset0:0 offset1:1
    ds_read_b32 v106, v7 offset:8
    ds_read2_b32 v[108:109], v7 offset0:96 offset1:97
    ds_read_b32 v110, v7 offset:392
    ds_read2_b32 v[112:113], v7 offset0:192 offset1:193
    ds_read_b32 v114, v7 offset:776
    s_waitcnt lgkmcnt(4)
    v_dot2_f32_bf16 v48, v104, s56, v88
    v_dot2_f32_bf16 v49, v104, s57, v24
    s_nop 1
    v_dot2_f32_bf16 v50, v105, s56, v89
    v_dot2_f32_bf16 v51, v105, s57, v25
    v_cvt_pk_bf16_f32 v116, v48, v49
    v_dot2_f32_bf16 v56, v116, s56, v141
    v_dot2_f32_bf16 v57, v116, s57, v141
    v_dot2_f32_bf16 v52, v106, s56, v90
    v_dot2_f32_bf16 v53, v106, s57, v26
    v_cvt_pk_bf16_f32 v117, v50, v51
    v_dot2_f32_bf16 v58, v117, s56, v141
    v_dot2_f32_bf16 v59, v117, s57, v141
    v_cvt_pk_bf16_f32 v128, v56, v57
    v_lshlrev_b32 v62, 16, v128
    v_and_b32 v63, 0xffff0000, v128
    v_pk_mul_f32 v[62:63], v[62:63], v[142:143] op_sel_hi:[1,0]
    v_cvt_pk_bf16_f32 v128, v62, v63
    s_waitcnt lgkmcnt(2)
    v_dot2_f32_bf16 v48, v108, s56, v91
    v_dot2_f32_bf16 v49, v108, s57, v28
    v_cvt_pk_bf16_f32 v118, v52, v53
    v_dot2_f32_bf16 v60, v118, s56, v141
    v_dot2_f32_bf16 v61, v118, s57, v141
    v_cvt_pk_bf16_f32 v129, v58, v59
    v_lshlrev_b32 v62, 16, v129
    v_and_b32 v63, 0xffff0000, v129
    v_pk_mul_f32 v[62:63], v[62:63], v[142:143] op_sel_hi:[1,0]
    v_cvt_pk_bf16_f32 v129, v62, v63
    v_dot2_f32_bf16 v50, v109, s56, v92
    v_dot2_f32_bf16 v51, v109, s57, v29
    v_cvt_pk_bf16_f32 v120, v48, v49
    v_dot2_f32_bf16 v56, v120, s56, v141
    v_dot2_f32_bf16 v57, v120, s57, v141
    v_cvt_pk_bf16_f32 v130, v60, v61
    v_lshlrev_b32 v62, 16, v130
    v_and_b32 v63, 0xffff0000, v130
    v_pk_mul_f32 v[62:63], v[62:63], v[142:143] op_sel_hi:[1,0]
    v_cvt_pk_bf16_f32 v130, v62, v63
    v_dot2_f32_bf16 v52, v110, s56, v93
    v_dot2_f32_bf16 v53, v110, s57, v30
    v_cvt_pk_bf16_f32 v121, v50, v51
    v_dot2_f32_bf16 v58, v121, s56, v141
    v_dot2_f32_bf16 v59, v121, s57, v141
    v_cvt_pk_bf16_f32 v132, v56, v57
    v_lshlrev_b32 v62, 16, v132
    v_and_b32 v63, 0xffff0000, v132
    v_pk_mul_f32 v[62:63], v[62:63], v[142:143] op_sel_hi:[1,0]
    v_cvt_pk_bf16_f32 v132, v62, v63
    s_waitcnt lgkmcnt(0)
    v_dot2_f32_bf16 v48, v112, s56, v94
    v_dot2_f32_bf16 v49, v112, s57, v32
    v_cvt_pk_bf16_f32 v122, v52, v53
    v_dot2_f32_bf16 v60, v122, s56, v141
    v_dot2_f32_bf16 v61, v122, s57, v141
    v_cvt_pk_bf16_f32 v133, v58, v59
    v_lshlrev_b32 v62, 16, v133
    v_and_b32 v63, 0xffff0000, v133
    v_pk_mul_f32 v[62:63], v[62:63], v[142:143] op_sel_hi:[1,0]
    v_cvt_pk_bf16_f32 v133, v62, v63
    v_dot2_f32_bf16 v50, v113, s56, v95
    v_dot2_f32_bf16 v51, v113, s57, v33
    v_cvt_pk_bf16_f32 v124, v48, v49
    v_dot2_f32_bf16 v56, v124, s56, v141
    v_dot2_f32_bf16 v57, v124, s57, v141
    v_cvt_pk_bf16_f32 v134, v60, v61
    v_lshlrev_b32 v62, 16, v134
    v_and_b32 v63, 0xffff0000, v134
    v_pk_mul_f32 v[62:63], v[62:63], v[142:143] op_sel_hi:[1,0]
    v_cvt_pk_bf16_f32 v134, v62, v63
    v_dot2_f32_bf16 v52, v114, s56, v96
    v_dot2_f32_bf16 v53, v114, s57, v34
    v_cvt_pk_bf16_f32 v125, v50, v51
    v_dot2_f32_bf16 v58, v125, s56, v141
    v_dot2_f32_bf16 v59, v125, s57, v141
    v_cvt_pk_bf16_f32 v136, v56, v57
    v_lshlrev_b32 v62, 16, v136
    v_and_b32 v63, 0xffff0000, v136
    v_pk_mul_f32 v[62:63], v[62:63], v[142:143] op_sel_hi:[1,0]
    v_cvt_pk_bf16_f32 v136, v62, v63
    v_cvt_pk_bf16_f32 v126, v52, v53
    v_dot2_f32_bf16 v60, v126, s56, v141
    v_dot2_f32_bf16 v61, v126, s57, v141
    v_cvt_pk_bf16_f32 v137, v58, v59
    v_lshlrev_b32 v62, 16, v137
    v_and_b32 v63, 0xffff0000, v137
    v_pk_mul_f32 v[62:63], v[62:63], v[142:143] op_sel_hi:[1,0]
    v_cvt_pk_bf16_f32 v137, v62, v63
    v_cvt_pk_bf16_f32 v138, v60, v61
    v_lshlrev_b32 v62, 16, v138
    v_and_b32 v63, 0xffff0000, v138
    v_pk_mul_f32 v[62:63], v[62:63], v[142:143] op_sel_hi:[1,0]
    v_cvt_pk_bf16_f32 v138, v62, v63
    s_cmp_lt_u32 s55, 2
    s_cbranch_scc1 KF_SL
KF_OC:

    v_lshlrev_b32 v50, 16, v128
    v_and_b32 v51, 0xffff0000, v128
    v_dot2_f32_bf16 v48, v116, s56, v50
    v_dot2_f32_bf16 v49, v116, s57, v51
    v_lshlrev_b32 v54, 16, v129
    v_and_b32 v55, 0xffff0000, v129
    v_dot2_f32_bf16 v52, v117, s56, v54
    v_dot2_f32_bf16 v53, v117, s57, v55
    v_cvt_pk_bf16_f32 v104, v48, v49
    v_lshlrev_b32 v50, 16, v130
    v_and_b32 v51, 0xffff0000, v130
    v_dot2_f32_bf16 v48, v118, s56, v50
    v_dot2_f32_bf16 v49, v118, s57, v51
    v_cvt_pk_bf16_f32 v105, v52, v53
    v_lshlrev_b32 v54, 16, v132
    v_and_b32 v55, 0xffff0000, v132
    v_dot2_f32_bf16 v52, v120, s56, v54
    v_dot2_f32_bf16 v53, v120, s57, v55
    v_cvt_pk_bf16_f32 v106, v48, v49
    v_lshlrev_b32 v50, 16, v133
    v_and_b32 v51, 0xffff0000, v133
    v_dot2_f32_bf16 v48, v121, s56, v50
    v_dot2_f32_bf16 v49, v121, s57, v51
    v_cvt_pk_bf16_f32 v108, v52, v53
    v_lshlrev_b32 v54, 16, v134
    v_and_b32 v55, 0xffff0000, v134
    v_dot2_f32_bf16 v52, v122, s56, v54
    v_dot2_f32_bf16 v53, v122, s57, v55
    v_cvt_pk_bf16_f32 v109, v48, v49
    v_lshlrev_b32 v50, 16, v136
    v_and_b32 v51, 0xffff0000, v136
    v_dot2_f32_bf16 v48, v124, s56, v50
    v_dot2_f32_bf16 v49, v124, s57, v51
    v_cvt_pk_bf16_f32 v110, v52, v53
    v_lshlrev_b32 v54, 16, v137
    v_and_b32 v55, 0xffff0000, v137
    v_dot2_f32_bf16 v52, v125, s56, v54
    v_dot2_f32_bf16 v53, v125, s57, v55
    v_cvt_pk_bf16_f32 v112, v48, v49
    v_lshlrev_b32 v50, 16, v138
    v_and_b32 v51, 0xffff0000, v138
    v_dot2_f32_bf16 v48, v126, s56, v50
    v_dot2_f32_bf16 v49, v126, s57, v51
    v_cvt_pk_bf16_f32 v113, v52, v53
    s_nop 2
    v_cvt_pk_bf16_f32 v114, v48, v49
    s_cmp_lt_u32 s55, 2
    s_cbranch_scc1 KF_SO
    s_cmp_ge_u32 s55, 99
    s_cbranch_scc1 KF_SO
KF_SL:

    s_mov_b32 s81, 0
SY21:
    ds_read_b32 v167, v164 offset:48
    s_add_u32 s81, s81, 1
    s_cmp_gt_u32 s81, 0x400000
    s_cbranch_scc1 SY21_D
    s_waitcnt lgkmcnt(0)
    v_readfirstlane_b32 s80, v167
    s_cmp_ge_u32 s80, 33554432
    s_cbranch_scc0 SY21
SY21_D:
    s_and_b32 s58, s80, 0xff
    s_cmp_ge_u32 s58, 8
    s_cbranch_scc1 KF_SD
    s_cmp_eq_u32 s52, s62
    s_cselect_b32 s18, -1, 0
    s_cmp_eq_u32 s53, s62
    s_cselect_b32 s19, -1, 0
    s_or_b64 s[60:61], s[60:61], s[18:19]
    s_cmp_eq_u64 s[18:19], 0
    s_cbranch_scc1 KF_NOSEL
    s_mov_b64 exec, s[18:19]
    s_mul_i32 s16, s58, 1152

    buffer_store_dwordx3 v[128:130], v3, s[40:43], s16 offen offset:0 sc0 sc1
    buffer_store_dwordx3 v[132:134], v3, s[40:43], s16 offen offset:384 sc0 sc1
    buffer_store_dwordx3 v[136:138], v3, s[40:43], s16 offen offset:768 sc0 sc1
    s_add_u32 s16, s16, 9216
    buffer_store_dwordx3 v[128:130], v3, s[40:43], s16 offen offset:0 sc0 sc1
    buffer_store_dwordx3 v[132:134], v3, s[40:43], s16 offen offset:384 sc0 sc1
    buffer_store_dwordx3 v[136:138], v3, s[40:43], s16 offen offset:768 sc0 sc1
    s_add_u32 s16, s16, 9216
    buffer_store_dwordx3 v[128:130], v3, s[40:43], s16 offen offset:0 sc0 sc1
    buffer_store_dwordx3 v[132:134], v3, s[40:43], s16 offen offset:384 sc0 sc1
    buffer_store_dwordx3 v[136:138], v3, s[40:43], s16 offen offset:768 sc0 sc1
    s_add_u32 s16, s16, 9216
    buffer_store_dwordx3 v[128:130], v3, s[40:43], s16 offen offset:0 sc0 sc1
    buffer_store_dwordx3 v[132:134], v3, s[40:43], s16 offen offset:384 sc0 sc1
    buffer_store_dwordx3 v[136:138], v3, s[40:43], s16 offen offset:768 sc0 sc1
    s_add_u32 s16, s16, 9216
    buffer_store_dwordx3 v[116:118], v3, s[40:43], s16 offen offset:0 sc0 sc1
    buffer_store_dwordx3 v[120:122], v3, s[40:43], s16 offen offset:384 sc0 sc1
    buffer_store_dwordx3 v[124:126], v3, s[40:43], s16 offen offset:768 sc0 sc1
    v_mov_b32 v8, 0
    s_lshl_b32 s16, s58, 2
    s_add_u32 s16, s16, 46080
    buffer_store_dword v143, v8, s[40:43], s16 offen sc0 sc1
    s_mov_b64 exec, -1

KF_NOSEL:
    v_add_u32 v164, 4, v164
    s_add_u32 s62, s62, 1
    s_cmp_le_u32 s62, s54
    s_cbranch_scc1 KF_SL
KF_SD:
    s_setprio 0
    s_cmp_lt_u32 s55, 2
    s_cbranch_scc1 KF_OC
KF_SO:
    s_sleep 32
    s_andn2_b64 exec, exec, s[60:61]

    buffer_store_dwordx3 v[104:106], v6, s[36:39], 0 offen offset:0 sc0 sc1
    buffer_store_dwordx3 v[108:110], v6, s[36:39], 0 offen offset:384 sc0 sc1
    buffer_store_dwordx3 v[112:114], v6, s[36:39], 0 offen offset:768 sc0 sc1
    s_mov_b64 exec, -1
    s_cmp_ge_u32 s20, 3
    s_cbranch_scc1 KF_FIN

    s_mov_b32 s2, s101
    s_cmp_ge_u32 s2, 72
    s_cbranch_scc1 KF_FIN

    s_mov_b32 s16, 0x1c71c71d
    s_mul_hi_u32 s62, s2, s16
    s_mul_i32 s18, s62, 9
    s_sub_u32 s61, s2, s18

    s_add_u32 s12, s30, 0x400000
    s_addc_u32 s13, s31, 0
    s_mov_b32 s14, 0xa2000
    s_mov_b32 s15, 0x00020000
    v_bfe_u32 v5, v1, 2, 2
    v_lshlrev_b32 v5, 4, v5
    v_lshrrev_b32 v6, 4, v1
    v_lshl_add_u32 v5, v6, 2, v5
    v_and_b32 v6, 3, v1

    s_lshl_b32 s19, s61, 6
    v_add3_u32 v5, v5, v6, s19
    v_lshlrev_b32 v7, 1, v5
    s_mul_i32 s16, s62, 1152
    s_and_b32 s17, s2, 3
    s_mul_i32 s17, s17, 9216
    s_add_u32 s17, s17, s16
    s_add_u32 s16, s16, 36864
    s_lshl_b32 s19, s62, 2
    s_add_u32 s19, s19, 46080
    v_mov_b32 v8, 0
    s_mov_b32 s63, 0
KF_K2_P:
    buffer_load_ushort v12, v7, s[40:43], s17 offen sc0 sc1
    buffer_load_ushort v13, v7, s[40:43], s16 offen sc0 sc1
    buffer_load_dword v14, v8, s[40:43], s19 offen sc0 sc1
    s_waitcnt vmcnt(0)
    v_lshrrev_b32 v10, 16, v14
    v_and_b32 v10, v10, v14
    v_max3_u32 v9, v12, v13, v10
    v_cmp_eq_u32 vcc, 0xffff, v9
    s_add_u32 s63, s63, 1
    s_cmp_gt_u32 s63, 200000
    s_cbranch_scc1 KF_K2_D
    s_cbranch_vccz KF_K2_D
    s_sleep 2
    s_branch KF_K2_P
KF_K2_D:
    v_readfirstlane_b32 s22, v14
    s_mul_i32 s21, s2, 9216
    v_lshlrev_b32 v6, 4, v0
    s_and_b32 s23, s22, 0x7ff
    s_sub_u32 s23, 0x7ff, s23
    s_mul_i32 s23, s23, 1152
    s_and_b32 s16, s22, 0xffff0000
    s_xor_b32 s60, s16, 0x80000000
    s_not_b32 s61, s16
    s_and_b32 s61, s61, 0xffff0000
    s_cmp_lt_i32 s22, 0
    s_cselect_b32 s60, s60, s61
    s_mov_b32 s63, 0

    v_lshrrev_b32 v10, 4, v0
    v_lshlrev_b32 v10, 8, v10
    v_and_b32 v11, 7, v1
    v_lshl_add_u32 v10, v11, 5, v10
    v_add_u32 v44, 80448, v10
    v_lshlrev_b32 v10, 2, v1
    v_add_u32 v45, 80448, v10
    s_mov_b32 s18, 0x00ff00ff
    s_mov_b32 s19, 0x00ff00ff
    v_mov_b32 v11, s60
    v_mul_f32 v11, 0xbfb8aa3b, v11
    v_exp_f32 v11, v11
    v_lshlrev_b32 v12, 16, v12
    v_add_f32 v11, 1.0, v11
    v_rcp_f32 v11, v11
    v_lshlrev_b32 v13, 16, v13

    v_cvt_pk_bf16_f32 v11, v11, v11
    v_lshlrev_b32 v11, 16, v11
    s_add_u32 s16, s21, 3072
    s_add_u32 s17, s21, 6144
    buffer_load_dwordx4 v[48:51], v6, s[12:15], s21 offen sc0 sc1
    buffer_load_dwordx4 v[52:55], v6, s[12:15], s16 offen sc0 sc1
    buffer_load_dwordx4 v[56:59], v6, s[12:15], s17 offen sc0 sc1
    s_sleep 5
    buffer_load_dwordx4 v[64:67], v6, s[12:15], s21 offen sc0 sc1
    buffer_load_dwordx4 v[68:71], v6, s[12:15], s16 offen sc0 sc1
    buffer_load_dwordx4 v[72:75], v6, s[12:15], s17 offen sc0 sc1
    s_sleep 5
KF_E_P:
    buffer_load_dwordx4 v[80:83], v6, s[12:15], s21 offen sc0 sc1
    buffer_load_dwordx4 v[84:87], v6, s[12:15], s16 offen sc0 sc1
    buffer_load_dwordx4 v[88:91], v6, s[12:15], s17 offen sc0 sc1
    s_waitcnt vmcnt(6)
    v_and_b32 v9, v48, v52
    v_and_b32 v9, v9, v56
    v_and_b32 v9, 1, v9
    v_cmp_eq_u32 vcc, 0, v9
    s_add_u32 s63, s63, 1
    s_cmp_gt_u32 s63, 200000
    s_cbranch_scc1 KF_E_D0
    s_cbranch_vccz KF_E_D0

    buffer_load_dwordx4 v[48:51], v6, s[12:15], s21 offen sc0 sc1
    buffer_load_dwordx4 v[52:55], v6, s[12:15], s16 offen sc0 sc1
    buffer_load_dwordx4 v[56:59], v6, s[12:15], s17 offen sc0 sc1
    s_waitcnt vmcnt(6)
    v_and_b32 v9, v64, v68
    v_and_b32 v9, v9, v72
    v_and_b32 v9, 1, v9
    v_cmp_eq_u32 vcc, 0, v9
    s_add_u32 s63, s63, 1
    s_cmp_gt_u32 s63, 200000
    s_cbranch_scc1 KF_E_D1
    s_cbranch_vccz KF_E_D1

    buffer_load_dwordx4 v[64:67], v6, s[12:15], s21 offen sc0 sc1
    buffer_load_dwordx4 v[68:71], v6, s[12:15], s16 offen sc0 sc1
    buffer_load_dwordx4 v[72:75], v6, s[12:15], s17 offen sc0 sc1
    s_waitcnt vmcnt(6)
    v_and_b32 v9, v80, v84
    v_and_b32 v9, v9, v88
    v_and_b32 v9, 1, v9
    v_cmp_eq_u32 vcc, 0, v9
    s_add_u32 s63, s63, 1
    s_cmp_gt_u32 s63, 200000
    s_cbranch_scc1 KF_E_D2
    s_cbranch_vccz KF_E_D2

    s_branch KF_E_P
KF_E_D0:
    v_lshlrev_b32 v32, 16, v48
    v_and_b32 v33, 0xffff0000, v48
    v_lshlrev_b32 v34, 16, v49
    v_and_b32 v35, 0xffff0000, v49
    v_lshlrev_b32 v36, 16, v50
    v_and_b32 v37, 0xffff0000, v50
    v_lshlrev_b32 v38, 16, v51
    v_and_b32 v39, 0xffff0000, v51
    v_lshlrev_b32 v40, 16, v52
    v_and_b32 v41, 0xffff0000, v52
    v_pk_add_f32 v[32:33], v[32:33], v[40:41]
    v_lshlrev_b32 v42, 16, v53
    v_and_b32 v43, 0xffff0000, v53
    v_pk_add_f32 v[34:35], v[34:35], v[42:43]
    v_lshlrev_b32 v40, 16, v54
    v_and_b32 v41, 0xffff0000, v54
    v_pk_add_f32 v[36:37], v[36:37], v[40:41]
    v_lshlrev_b32 v42, 16, v55
    v_and_b32 v43, 0xffff0000, v55
    v_pk_add_f32 v[38:39], v[38:39], v[42:43]
    v_lshlrev_b32 v40, 16, v56
    v_and_b32 v41, 0xffff0000, v56
    v_pk_add_f32 v[32:33], v[32:33], v[40:41]
    v_lshlrev_b32 v42, 16, v57
    v_and_b32 v43, 0xffff0000, v57
    v_pk_add_f32 v[34:35], v[34:35], v[42:43]
    v_lshlrev_b32 v40, 16, v58
    v_and_b32 v41, 0xffff0000, v58
    v_pk_add_f32 v[36:37], v[36:37], v[40:41]
    v_lshlrev_b32 v42, 16, v59
    v_and_b32 v43, 0xffff0000, v59
    v_pk_add_f32 v[38:39], v[38:39], v[42:43]
    s_branch KF_E_D
KF_E_D1:
    v_lshlrev_b32 v32, 16, v64
    v_and_b32 v33, 0xffff0000, v64
    v_lshlrev_b32 v34, 16, v65
    v_and_b32 v35, 0xffff0000, v65
    v_lshlrev_b32 v36, 16, v66
    v_and_b32 v37, 0xffff0000, v66
    v_lshlrev_b32 v38, 16, v67
    v_and_b32 v39, 0xffff0000, v67
    v_lshlrev_b32 v40, 16, v68
    v_and_b32 v41, 0xffff0000, v68
    v_pk_add_f32 v[32:33], v[32:33], v[40:41]
    v_lshlrev_b32 v42, 16, v69
    v_and_b32 v43, 0xffff0000, v69
    v_pk_add_f32 v[34:35], v[34:35], v[42:43]
    v_lshlrev_b32 v40, 16, v70
    v_and_b32 v41, 0xffff0000, v70
    v_pk_add_f32 v[36:37], v[36:37], v[40:41]
    v_lshlrev_b32 v42, 16, v71
    v_and_b32 v43, 0xffff0000, v71
    v_pk_add_f32 v[38:39], v[38:39], v[42:43]
    v_lshlrev_b32 v40, 16, v72
    v_and_b32 v41, 0xffff0000, v72
    v_pk_add_f32 v[32:33], v[32:33], v[40:41]
    v_lshlrev_b32 v42, 16, v73
    v_and_b32 v43, 0xffff0000, v73
    v_pk_add_f32 v[34:35], v[34:35], v[42:43]
    v_lshlrev_b32 v40, 16, v74
    v_and_b32 v41, 0xffff0000, v74
    v_pk_add_f32 v[36:37], v[36:37], v[40:41]
    v_lshlrev_b32 v42, 16, v75
    v_and_b32 v43, 0xffff0000, v75
    v_pk_add_f32 v[38:39], v[38:39], v[42:43]
    s_branch KF_E_D
KF_E_D2:
    v_lshlrev_b32 v32, 16, v80
    v_and_b32 v33, 0xffff0000, v80
    v_lshlrev_b32 v34, 16, v81
    v_and_b32 v35, 0xffff0000, v81
    v_lshlrev_b32 v36, 16, v82
    v_and_b32 v37, 0xffff0000, v82
    v_lshlrev_b32 v38, 16, v83
    v_and_b32 v39, 0xffff0000, v83
    v_lshlrev_b32 v40, 16, v84
    v_and_b32 v41, 0xffff0000, v84
    v_pk_add_f32 v[32:33], v[32:33], v[40:41]
    v_lshlrev_b32 v42, 16, v85
    v_and_b32 v43, 0xffff0000, v85
    v_pk_add_f32 v[34:35], v[34:35], v[42:43]
    v_lshlrev_b32 v40, 16, v86
    v_and_b32 v41, 0xffff0000, v86
    v_pk_add_f32 v[36:37], v[36:37], v[40:41]
    v_lshlrev_b32 v42, 16, v87
    v_and_b32 v43, 0xffff0000, v87
    v_pk_add_f32 v[38:39], v[38:39], v[42:43]
    v_lshlrev_b32 v40, 16, v88
    v_and_b32 v41, 0xffff0000, v88
    v_pk_add_f32 v[32:33], v[32:33], v[40:41]
    v_lshlrev_b32 v42, 16, v89
    v_and_b32 v43, 0xffff0000, v89
    v_pk_add_f32 v[34:35], v[34:35], v[42:43]
    v_lshlrev_b32 v40, 16, v90
    v_and_b32 v41, 0xffff0000, v90
    v_pk_add_f32 v[36:37], v[36:37], v[40:41]
    v_lshlrev_b32 v42, 16, v91
    v_and_b32 v43, 0xffff0000, v91
    v_pk_add_f32 v[38:39], v[38:39], v[42:43]
KF_E_D:
    s_nop 1
    v_add_f32_dpp v16, v32, v32 row_ror:8 row_mask:0xf bank_mask:0xf
    v_add_f32_dpp v17, v33, v33 row_ror:8 row_mask:0xf bank_mask:0xf
    v_add_f32_dpp v18, v34, v34 row_ror:8 row_mask:0xf bank_mask:0xf
    v_add_f32_dpp v19, v35, v35 row_ror:8 row_mask:0xf bank_mask:0xf
    v_add_f32_dpp v20, v36, v36 row_ror:8 row_mask:0xf bank_mask:0xf
    v_add_f32_dpp v21, v37, v37 row_ror:8 row_mask:0xf bank_mask:0xf
    v_add_f32_dpp v22, v38, v38 row_ror:8 row_mask:0xf bank_mask:0xf
    v_add_f32_dpp v23, v39, v39 row_ror:8 row_mask:0xf bank_mask:0xf
    s_mov_b64 exec, s[18:19]
    ds_write_b128 v44, v[16:19]
    ds_write_b128 v44, v[20:23] offset:16
    s_mov_b64 exec, -1
    s_cmp_lg_u32 s20, 0
    s_waitcnt lgkmcnt(0)
    s_barrier
    s_cbranch_scc1 KF_FIN

    ds_read2st64_b32 v[16:17], v45 offset0:0 offset1:1
    ds_read2st64_b32 v[18:19], v45 offset0:2 offset1:3
    ds_read2st64_b32 v[20:21], v45 offset0:4 offset1:5
    ds_read2st64_b32 v[22:23], v45 offset0:6 offset1:7
    ds_read2st64_b32 v[24:25], v45 offset0:8 offset1:9
    ds_read2st64_b32 v[26:27], v45 offset0:10 offset1:11
    s_waitcnt lgkmcnt(4)
    v_pk_add_f32 v[16:17], v[16:17], v[18:19]
    s_waitcnt lgkmcnt(2)
    v_pk_add_f32 v[20:21], v[20:21], v[22:23]
    v_pk_add_f32 v[16:17], v[16:17], v[20:21]
    s_waitcnt lgkmcnt(0)
    v_pk_add_f32 v[24:25], v[24:25], v[26:27]
    v_pk_add_f32 v[16:17], v[16:17], v[24:25]
    v_add_f32 v16, v16, v17

    v_cvt_pk_bf16_f32 v16, v16, v16
    v_lshlrev_b32 v16, 16, v16
    v_mul_f32 v16, v16, v11
    v_cvt_pk_bf16_f32 v16, v16, v16
    v_lshlrev_b32 v16, 16, v16
    v_add_f32 v16, v16, v12
    v_cvt_pk_bf16_f32 v16, v16, v16
    v_lshlrev_b32 v16, 16, v16
    v_add_f32 v16, v16, v13
    v_cvt_pk_bf16_f32 v16, v16, v16
    buffer_store_short v16, v7, s[36:39], s23 offen sc0 sc1
    s_branch KF_FIN

C_RK:

    v_mov_b32 v20, v15
    v_lshlrev_b32 v2, 4, v1
    s_and_b32 s23, s2, 3
    s_lshl_b32 s23, s23, 13
    s_and_b32 s21, s20, 1
    s_lshl_b32 s21, s21, 12
    s_add_u32 s23, s23, s21
    s_mov_b32 s63, 0

    buffer_load_dwordx4 v[24:27], v2, s[48:51], s23 offen offset:0 sc0 sc1
    buffer_load_dwordx4 v[28:31], v2, s[48:51], s23 offen offset:1024 sc0 sc1
    buffer_load_dwordx4 v[32:35], v2, s[48:51], s23 offen offset:2048 sc0 sc1
    buffer_load_dwordx4 v[36:39], v2, s[48:51], s23 offen offset:3072 sc0 sc1
    v_mov_b32 v23, v20
    s_nop 1
    v_max_u32_dpp v23, v23, v23 row_ror:8 row_mask:0xf bank_mask:0xf
    s_nop 1
    v_max_u32_dpp v23, v23, v23 row_ror:4 row_mask:0xf bank_mask:0xf
    s_nop 1
    v_max_u32_dpp v23, v23, v23 row_ror:2 row_mask:0xf bank_mask:0xf
    s_nop 1
    v_max_u32_dpp v23, v23, v23 row_ror:1 row_mask:0xf bank_mask:0xf
    s_nop 0
    v_readfirstlane_b32 s52, v23
    v_cmp_eq_u32 vcc, v23, v20
    s_nop 0
    v_cndmask_b32 v20, v20, 0, vcc

    s_setprio 3
    s_waitcnt lgkmcnt(0)
    s_barrier
    s_branch KF_K_C
KF_K_P:
    buffer_load_dwordx4 v[24:27], v2, s[48:51], s23 offen offset:0 sc0 sc1
    buffer_load_dwordx4 v[28:31], v2, s[48:51], s23 offen offset:1024 sc0 sc1
    buffer_load_dwordx4 v[32:35], v2, s[48:51], s23 offen offset:2048 sc0 sc1
    buffer_load_dwordx4 v[36:39], v2, s[48:51], s23 offen offset:3072 sc0 sc1
KF_K_C:
    s_waitcnt vmcnt(0)
    v_max3_u32 v9, v24, v25, v26
    v_max3_u32 v9, v9, v27, v28
    v_max3_u32 v9, v9, v29, v30
    v_max3_u32 v9, v9, v31, v32
    v_max3_u32 v9, v9, v33, v34
    v_max3_u32 v9, v9, v35, v36
    v_max3_u32 v9, v9, v37, v38
    v_max_u32 v9, v9, v39
    v_cmp_eq_u32 vcc, -1, v9
    s_add_u32 s63, s63, 1
    s_cmp_gt_u32 s63, 200000
    s_cbranch_scc1 KF_K_D
    s_cbranch_vccz KF_K_D
    s_sleep 2
    s_branch KF_K_P
KF_K_D:

KF_RL:
    s_mov_b32 s21, 0
    v_cmp_lt_u32 s[32:33], s52, v24
    v_cmp_lt_u32 s[34:35], s52, v25
    v_cmp_lt_u32 s[36:37], s52, v26
    v_cmp_lt_u32 s[38:39], s52, v27
    s_bcnt1_i32_b64 s56, s[32:33]
    s_bcnt1_i32_b64 s57, s[34:35]
    s_bcnt1_i32_b64 s58, s[36:37]
    s_bcnt1_i32_b64 s59, s[38:39]
    s_add_u32 s56, s56, s57
    s_add_u32 s58, s58, s59
    s_add_u32 s21, s21, s56
    s_add_u32 s21, s21, s58

    v_cmp_lt_u32 s[32:33], s52, v28
    v_cmp_lt_u32 s[34:35], s52, v29
    v_cmp_lt_u32 s[36:37], s52, v30
    v_cmp_lt_u32 s[38:39], s52, v31
    s_bcnt1_i32_b64 s56, s[32:33]
    s_bcnt1_i32_b64 s57, s[34:35]
    s_bcnt1_i32_b64 s58, s[36:37]
    s_bcnt1_i32_b64 s59, s[38:39]
    s_add_u32 s56, s56, s57
    s_add_u32 s58, s58, s59
    s_add_u32 s21, s21, s56
    s_add_u32 s21, s21, s58

    v_cmp_lt_u32 s[32:33], s52, v32
    v_cmp_lt_u32 s[34:35], s52, v33
    v_cmp_lt_u32 s[36:37], s52, v34
    v_cmp_lt_u32 s[38:39], s52, v35
    s_bcnt1_i32_b64 s56, s[32:33]
    s_bcnt1_i32_b64 s57, s[34:35]
    s_bcnt1_i32_b64 s58, s[36:37]
    s_bcnt1_i32_b64 s59, s[38:39]
    s_add_u32 s56, s56, s57
    s_add_u32 s58, s58, s59
    s_add_u32 s21, s21, s56
    s_add_u32 s21, s21, s58

    v_cmp_lt_u32 s[32:33], s52, v36
    v_cmp_lt_u32 s[34:35], s52, v37
    v_cmp_lt_u32 s[36:37], s52, v38
    v_cmp_lt_u32 s[38:39], s52, v39
    s_bcnt1_i32_b64 s56, s[32:33]
    s_bcnt1_i32_b64 s57, s[34:35]
    s_bcnt1_i32_b64 s58, s[36:37]
    s_bcnt1_i32_b64 s59, s[38:39]
    s_add_u32 s56, s56, s57
    s_add_u32 s58, s58, s59
    s_add_u32 s21, s21, s56
    s_add_u32 s21, s21, s58

    s_min_u32 s21, s21, 8
    s_add_u32 s21, s21, 0x1000000
    v_mov_b32 v23, s21
    s_mov_b64 exec, 1
    ds_add_u32 v164, v23 offset:48
    s_mov_b64 exec, -1

    v_mov_b32 v23, v20
    s_nop 1
    v_max_u32_dpp v23, v23, v23 row_ror:8 row_mask:0xf bank_mask:0xf
    s_nop 1
    v_max_u32_dpp v23, v23, v23 row_ror:4 row_mask:0xf bank_mask:0xf
    s_nop 1
    v_max_u32_dpp v23, v23, v23 row_ror:2 row_mask:0xf bank_mask:0xf
    s_nop 1
    v_max_u32_dpp v23, v23, v23 row_ror:1 row_mask:0xf bank_mask:0xf
    s_nop 0
    v_readfirstlane_b32 s52, v23
    v_cmp_eq_u32 vcc, v23, v20
    s_nop 0
    v_cndmask_b32 v20, v20, 0, vcc

    s_mov_b32 s81, 0
SY22:
    ds_read_b32 v167, v164 offset:48
    s_add_u32 s81, s81, 1
    s_cmp_gt_u32 s81, 0x400000
    s_cbranch_scc1 SY22_D
    s_waitcnt lgkmcnt(0)
    v_readfirstlane_b32 s80, v167
    s_cmp_ge_u32 s80, 33554432
    s_cbranch_scc0 SY22
SY22_D:
    s_and_b32 s58, s80, 0xff
    v_add_u32 v164, 4, v164
    s_add_u32 s62, s62, 1
    s_cmp_ge_u32 s62, 8
    s_cbranch_scc1 KF_FIN
    s_cmp_lt_u32 s58, 8
    s_cbranch_scc1 KF_RL

    s_branch KF_FIN
KF_D:
    s_setprio 0
    s_waitcnt lgkmcnt(0)
    s_load_dwordx4 s[24:27], s[0:1], 40
    s_load_dwordx2 s[28:29], s[0:1], 56
    s_cmp_lt_u32 s2, 184
    s_cbranch_scc1 KF_H
    s_sub_u32 s3, s2, 184
    s_and_b32 s16, s3, 7
    s_mul_i32 s16, s16, 9
    s_lshr_b32 s3, s3, 3
    s_add_u32 s3, s3, s16
    s_lshr_b32 s21, s20, 1
    s_lshl_b32 s21, s21, 2
    s_lshr_b32 s21, 0x02134, s21
    s_and_b32 s21, s21, 7
    v_lshrrev_b32 v10, 4, v1
    v_lshlrev_b32 v7, 4, v1
    v_mul_u32_u24 v5, 73728, v10
    v_and_b32 v3, 15, v1
    v_lshl_add_u32 v5, v3, 3, v5
    s_lshl_b32 s16, s3, 7
    v_add_u32 v5, s16, v5
    s_mul_i32 s17, s21, 294912
    s_mul_i32 s18, s3, 73728
    s_mov_b32 s22, 0x05040100
    s_mov_b32 s23, 0x07060302
    s_bitcmp1_b32 s20, 0
    s_waitcnt lgkmcnt(0)
    s_cselect_b32 s24, s26, s24
    s_cselect_b32 s25, s27, s25

    s_mov_b32 s4, s24
    s_mov_b32 s5, s25
    s_mov_b32 s6, 0x510000
    s_mov_b32 s7, 0x00020000
    s_mov_b32 s12, s28
    s_mov_b32 s13, s29
    s_mov_b32 s14, 0x510000
    s_mov_b32 s15, 0x00020000
    s_cmp_lg_u32 s20, 8
    s_cbranch_scc1 KF_DG

    s_mov_b32 m0, 0
    buffer_load_dwordx4 v7, s[12:15], s18 offen offset:0 lds
    buffer_load_dwordx4 v7, s[12:15], s18 offen offset:1024 lds
    buffer_load_dwordx4 v7, s[12:15], s18 offen offset:2048 lds
    buffer_load_dwordx4 v7, s[12:15], s18 offen offset:3072 lds
    s_add_u32 s18, s18, 4096
    s_mov_b32 m0, 4096
    buffer_load_dwordx4 v7, s[12:15], s18 offen offset:0 lds
    buffer_load_dwordx4 v7, s[12:15], s18 offen offset:1024 lds
    buffer_load_dwordx4 v7, s[12:15], s18 offen offset:2048 lds
    buffer_load_dwordx4 v7, s[12:15], s18 offen offset:3072 lds
    s_add_u32 s18, s18, 4096
    s_mov_b32 m0, 8192
    buffer_load_dwordx4 v7, s[12:15], s18 offen offset:0 lds
    buffer_load_dwordx4 v7, s[12:15], s18 offen offset:1024 lds
    buffer_load_dwordx4 v7, s[12:15], s18 offen offset:2048 lds
    buffer_load_dwordx4 v7, s[12:15], s18 offen offset:3072 lds
    s_add_u32 s18, s18, 4096
    s_mov_b32 m0, 12288
    buffer_load_dwordx4 v7, s[12:15], s18 offen offset:0 lds
    buffer_load_dwordx4 v7, s[12:15], s18 offen offset:1024 lds
    buffer_load_dwordx4 v7, s[12:15], s18 offen offset:2048 lds
    buffer_load_dwordx4 v7, s[12:15], s18 offen offset:3072 lds
    s_add_u32 s18, s18, 4096
    s_mov_b32 m0, 16384
    buffer_load_dwordx4 v7, s[12:15], s18 offen offset:0 lds
    buffer_load_dwordx4 v7, s[12:15], s18 offen offset:1024 lds
    buffer_load_dwordx4 v7, s[12:15], s18 offen offset:2048 lds
    buffer_load_dwordx4 v7, s[12:15], s18 offen offset:3072 lds
    s_add_u32 s18, s18, 4096
    s_mov_b32 m0, 20480
    buffer_load_dwordx4 v7, s[12:15], s18 offen offset:0 lds
    buffer_load_dwordx4 v7, s[12:15], s18 offen offset:1024 lds
    buffer_load_dwordx4 v7, s[12:15], s18 offen offset:2048 lds
    buffer_load_dwordx4 v7, s[12:15], s18 offen offset:3072 lds
    s_add_u32 s18, s18, 4096
    s_mov_b32 m0, 24576
    buffer_load_dwordx4 v7, s[12:15], s18 offen offset:0 lds
    buffer_load_dwordx4 v7, s[12:15], s18 offen offset:1024 lds
    buffer_load_dwordx4 v7, s[12:15], s18 offen offset:2048 lds
    buffer_load_dwordx4 v7, s[12:15], s18 offen offset:3072 lds
    s_add_u32 s18, s18, 4096
    s_mov_b32 m0, 28672
    buffer_load_dwordx4 v7, s[12:15], s18 offen offset:0 lds
    buffer_load_dwordx4 v7, s[12:15], s18 offen offset:1024 lds
    buffer_load_dwordx4 v7, s[12:15], s18 offen offset:2048 lds
    buffer_load_dwordx4 v7, s[12:15], s18 offen offset:3072 lds
    s_add_u32 s18, s18, 4096
    s_waitcnt vmcnt(31)
    s_mov_b32 m0, 32768
    buffer_load_dwordx4 v7, s[12:15], s18 offen offset:0 lds
    s_waitcnt vmcnt(31)
    buffer_load_dwordx4 v7, s[12:15], s18 offen offset:1024 lds
    s_waitcnt vmcnt(31)
    buffer_load_dwordx4 v7, s[12:15], s18 offen offset:2048 lds
    s_waitcnt vmcnt(31)
    buffer_load_dwordx4 v7, s[12:15], s18 offen offset:3072 lds
    s_add_u32 s18, s18, 4096
    s_waitcnt vmcnt(31)
    s_mov_b32 m0, 36864
    buffer_load_dwordx4 v7, s[12:15], s18 offen offset:0 lds
    s_waitcnt vmcnt(31)
    buffer_load_dwordx4 v7, s[12:15], s18 offen offset:1024 lds
    s_waitcnt vmcnt(31)
    buffer_load_dwordx4 v7, s[12:15], s18 offen offset:2048 lds
    s_waitcnt vmcnt(31)
    buffer_load_dwordx4 v7, s[12:15], s18 offen offset:3072 lds
    s_add_u32 s18, s18, 4096
    s_waitcnt vmcnt(31)
    s_mov_b32 m0, 40960
    buffer_load_dwordx4 v7, s[12:15], s18 offen offset:0 lds
    s_waitcnt vmcnt(31)
    buffer_load_dwordx4 v7, s[12:15], s18 offen offset:1024 lds
    s_waitcnt vmcnt(31)
    buffer_load_dwordx4 v7, s[12:15], s18 offen offset:2048 lds
    s_waitcnt vmcnt(31)
    buffer_load_dwordx4 v7, s[12:15], s18 offen offset:3072 lds
    s_add_u32 s18, s18, 4096
    s_waitcnt vmcnt(31)
    s_mov_b32 m0, 45056
    buffer_load_dwordx4 v7, s[12:15], s18 offen offset:0 lds
    s_waitcnt vmcnt(31)
    buffer_load_dwordx4 v7, s[12:15], s18 offen offset:1024 lds
    s_waitcnt vmcnt(31)
    buffer_load_dwordx4 v7, s[12:15], s18 offen offset:2048 lds
    s_waitcnt vmcnt(31)
    buffer_load_dwordx4 v7, s[12:15], s18 offen offset:3072 lds
    s_add_u32 s18, s18, 4096
    s_mov_b32 s81, 0
SY23:
    ds_read_b32 v167, v165 offset:28
    s_add_u32 s81, s81, 1
    s_cmp_gt_u32 s81, 0x400000
    s_cbranch_scc1 SY23_D
    s_waitcnt lgkmcnt(0)
    v_readfirstlane_b32 s80, v167
    s_cmp_ge_u32 s80, 4
    s_cbranch_scc1 SY23_D
    s_sleep 2
    s_branch SY23
SY23_D:
    s_waitcnt vmcnt(31)
    s_mov_b32 m0, 49152
    buffer_load_dwordx4 v7, s[12:15], s18 offen offset:0 lds
    s_waitcnt vmcnt(31)
    buffer_load_dwordx4 v7, s[12:15], s18 offen offset:1024 lds
    s_waitcnt vmcnt(31)
    buffer_load_dwordx4 v7, s[12:15], s18 offen offset:2048 lds
    s_waitcnt vmcnt(31)
    buffer_load_dwordx4 v7, s[12:15], s18 offen offset:3072 lds
    s_add_u32 s18, s18, 4096
    s_waitcnt vmcnt(31)
    s_mov_b32 m0, 53248
    buffer_load_dwordx4 v7, s[12:15], s18 offen offset:0 lds
    s_waitcnt vmcnt(31)
    buffer_load_dwordx4 v7, s[12:15], s18 offen offset:1024 lds
    s_waitcnt vmcnt(31)
    buffer_load_dwordx4 v7, s[12:15], s18 offen offset:2048 lds
    s_waitcnt vmcnt(31)
    buffer_load_dwordx4 v7, s[12:15], s18 offen offset:3072 lds
    s_add_u32 s18, s18, 4096
    s_waitcnt vmcnt(31)
    s_mov_b32 m0, 57344
    buffer_load_dwordx4 v7, s[12:15], s18 offen offset:0 lds
    s_waitcnt vmcnt(31)
    buffer_load_dwordx4 v7, s[12:15], s18 offen offset:1024 lds
    s_waitcnt vmcnt(31)
    buffer_load_dwordx4 v7, s[12:15], s18 offen offset:2048 lds
    s_waitcnt vmcnt(31)
    buffer_load_dwordx4 v7, s[12:15], s18 offen offset:3072 lds
    s_add_u32 s18, s18, 4096
    s_waitcnt vmcnt(31)
    s_mov_b32 m0, 61440
    buffer_load_dwordx4 v7, s[12:15], s18 offen offset:0 lds
    s_waitcnt vmcnt(31)
    buffer_load_dwordx4 v7, s[12:15], s18 offen offset:1024 lds
    s_waitcnt vmcnt(31)
    buffer_load_dwordx4 v7, s[12:15], s18 offen offset:2048 lds
    s_waitcnt vmcnt(31)
    buffer_load_dwordx4 v7, s[12:15], s18 offen offset:3072 lds
    s_add_u32 s18, s18, 4096
    s_waitcnt vmcnt(31)
    s_mov_b32 m0, 65536
    buffer_load_dwordx4 v7, s[12:15], s18 offen offset:0 lds
    s_waitcnt vmcnt(31)
    buffer_load_dwordx4 v7, s[12:15], s18 offen offset:1024 lds
    s_waitcnt vmcnt(31)
    buffer_load_dwordx4 v7, s[12:15], s18 offen offset:2048 lds
    s_waitcnt vmcnt(31)
    buffer_load_dwordx4 v7, s[12:15], s18 offen offset:3072 lds
    s_add_u32 s18, s18, 4096
    s_waitcnt vmcnt(31)
    s_mov_b32 m0, 69632
    buffer_load_dwordx4 v7, s[12:15], s18 offen offset:0 lds
    s_waitcnt vmcnt(31)
    buffer_load_dwordx4 v7, s[12:15], s18 offen offset:1024 lds
    s_waitcnt vmcnt(31)
    buffer_load_dwordx4 v7, s[12:15], s18 offen offset:2048 lds
    s_waitcnt vmcnt(31)
    buffer_load_dwordx4 v7, s[12:15], s18 offen offset:3072 lds
    s_add_u32 s18, s18, 4096
KF_DG:
    s_mov_b32 s81, 0
SY24:
    ds_read_b32 v167, v165 offset:32
    s_add_u32 s81, s81, 1
    s_cmp_gt_u32 s81, 0x400000
    s_cbranch_scc1 SY24_D
    s_waitcnt lgkmcnt(0)
    v_readfirstlane_b32 s80, v167
    s_cmp_ge_u32 s80, 4
    s_cbranch_scc1 SY24_D
    s_sleep 2
    s_branch SY24
SY24_D:
    s_movk_i32 s19, 0xf0
    s_bitcmp0_b32 s19, s20
    s_cbranch_scc1 KF_DPR1
    s_setprio 1
KF_DPR1:
    buffer_load_dwordx2 v[32:33], v5, s[4:7], s17 offen
    s_add_u32 s17, s17, 9216
    buffer_load_dwordx2 v[34:35], v5, s[4:7], s17 offen
    s_add_u32 s17, s17, 9216
    buffer_load_dwordx2 v[36:37], v5, s[4:7], s17 offen
    s_add_u32 s17, s17, 9216
    buffer_load_dwordx2 v[38:39], v5, s[4:7], s17 offen
    s_add_u32 s17, s17, 9216
    buffer_load_dwordx2 v[40:41], v5, s[4:7], s17 offen
    s_add_u32 s17, s17, 9216
    buffer_load_dwordx2 v[42:43], v5, s[4:7], s17 offen
    s_add_u32 s17, s17, 9216
    buffer_load_dwordx2 v[44:45], v5, s[4:7], s17 offen
    s_add_u32 s17, s17, 9216
    buffer_load_dwordx2 v[46:47], v5, s[4:7], s17 offen
    s_add_u32 s17, s17, 1410048
    buffer_load_dwordx2 v[48:49], v5, s[4:7], s17 offen
    s_add_u32 s17, s17, 9216
    buffer_load_dwordx2 v[50:51], v5, s[4:7], s17 offen
    s_add_u32 s17, s17, 9216
    buffer_load_dwordx2 v[52:53], v5, s[4:7], s17 offen
    s_add_u32 s17, s17, 9216
    buffer_load_dwordx2 v[54:55], v5, s[4:7], s17 offen
    s_add_u32 s17, s17, 9216
    buffer_load_dwordx2 v[56:57], v5, s[4:7], s17 offen
    s_add_u32 s17, s17, 9216
    buffer_load_dwordx2 v[58:59], v5, s[4:7], s17 offen
    s_add_u32 s17, s17, 9216
    buffer_load_dwordx2 v[60:61], v5, s[4:7], s17 offen
    s_add_u32 s17, s17, 9216
    buffer_load_dwordx2 v[62:63], v5, s[4:7], s17 offen
    s_add_u32 s17, s17, 1410048
    s_cmp_lt_u32 s20, 2
    s_cbranch_scc1 KF_DG1
    s_waitcnt vmcnt(15)
    s_cmp_lg_u32 s20, 8
    s_cbranch_scc1 KF_NDE
    s_mov_b64 exec, 1
    ds_add_u32 v165, v166 offset:52
    s_mov_b64 exec, -1
KF_NDE:
    buffer_load_dwordx2 v[64:65], v5, s[4:7], s17 offen
    s_add_u32 s17, s17, 9216
    s_waitcnt vmcnt(15)
    buffer_load_dwordx2 v[66:67], v5, s[4:7], s17 offen
    s_add_u32 s17, s17, 9216
    s_waitcnt vmcnt(15)
    buffer_load_dwordx2 v[68:69], v5, s[4:7], s17 offen
    s_add_u32 s17, s17, 9216
    s_waitcnt vmcnt(15)
    buffer_load_dwordx2 v[70:71], v5, s[4:7], s17 offen
    s_add_u32 s17, s17, 9216
    s_waitcnt vmcnt(15)
    buffer_load_dwordx2 v[72:73], v5, s[4:7], s17 offen
    s_add_u32 s17, s17, 9216
    s_waitcnt vmcnt(15)
    buffer_load_dwordx2 v[74:75], v5, s[4:7], s17 offen
    s_add_u32 s17, s17, 9216
    s_waitcnt vmcnt(15)
    buffer_load_dwordx2 v[76:77], v5, s[4:7], s17 offen
    s_add_u32 s17, s17, 9216
    s_waitcnt vmcnt(15)
    buffer_load_dwordx2 v[78:79], v5, s[4:7], s17 offen
    s_add_u32 s17, s17, 1115136
    s_waitcnt vmcnt(15)
    buffer_load_dwordx2 v[80:81], v5, s[4:7], s17 offen
    s_add_u32 s17, s17, 9216
    s_waitcnt vmcnt(15)
    buffer_load_dwordx2 v[82:83], v5, s[4:7], s17 offen
    s_add_u32 s17, s17, 9216
    s_waitcnt vmcnt(15)
    buffer_load_dwordx2 v[84:85], v5, s[4:7], s17 offen
    s_add_u32 s17, s17, 9216
    s_waitcnt vmcnt(15)
    buffer_load_dwordx2 v[86:87], v5, s[4:7], s17 offen
    s_add_u32 s17, s17, 9216
    s_waitcnt vmcnt(15)
    buffer_load_dwordx2 v[88:89], v5, s[4:7], s17 offen
    s_add_u32 s17, s17, 9216
    s_waitcnt vmcnt(15)
    buffer_load_dwordx2 v[90:91], v5, s[4:7], s17 offen
    s_add_u32 s17, s17, 9216
    s_waitcnt vmcnt(15)
    buffer_load_dwordx2 v[92:93], v5, s[4:7], s17 offen
    s_add_u32 s17, s17, 9216
    s_waitcnt vmcnt(15)
    buffer_load_dwordx2 v[94:95], v5, s[4:7], s17 offen
    s_add_u32 s17, s17, 1115136
KF_DG1:
    s_mov_b64 exec, 1
    ds_add_u32 v165, v166 offset:48
    s_mov_b64 exec, -1
    v_bfe_u32 v11, v1, 2, 2
    v_and_b32 v12, 3, v1
    v_lshl_add_u32 v13, v10, 3, v11
    v_mul_u32_u24 v6, 1152, v13
    v_lshl_add_u32 v6, v12, 3, v6
    s_lshl_b32 s18, s20, 7
    v_add_u32 v6, s18, v6
    v_and_b32 v2, 7, v1
    v_mul_u32_u24 v2, 1168, v2
    v_lshl_add_u32 v2, v10, 4, v2
    s_lshl_b32 s18, s21, 6
    s_add_u32 s18, s18, 0x17500
    v_add_u32 v2, s18, v2
    s_and_b32 s16, s20, 1
    s_mul_i32 s16, s16, 5
    s_add_u32 s16, s16, s21
    s_lshl_b32 s16, s16, 11
    s_add_u32 s16, s16, 0x12000
    v_lshlrev_b32 v3, 5, v3
    v_lshl_add_u32 v3, v10, 4, v3
    v_add_u32 v3, s16, v3
    s_waitcnt vmcnt(0)

    v_perm_b32 v16, v34, v32, s22
    v_perm_b32 v17, v38, v36, s22
    v_perm_b32 v18, v42, v40, s22
    v_perm_b32 v19, v46, v44, s22
    v_perm_b32 v20, v34, v32, s23
    v_perm_b32 v21, v38, v36, s23
    v_perm_b32 v22, v42, v40, s23
    v_perm_b32 v23, v46, v44, s23
    v_perm_b32 v24, v35, v33, s22
    v_perm_b32 v25, v39, v37, s22
    v_perm_b32 v26, v43, v41, s22
    v_perm_b32 v27, v47, v45, s22
    v_perm_b32 v28, v35, v33, s23
    v_perm_b32 v29, v39, v37, s23
    v_perm_b32 v30, v43, v41, s23
    v_perm_b32 v31, v47, v45, s23
    v_perm_b32 v32, v50, v48, s22
    v_perm_b32 v33, v54, v52, s22
    v_perm_b32 v34, v58, v56, s22
    v_perm_b32 v35, v62, v60, s22
    v_perm_b32 v36, v50, v48, s23
    v_perm_b32 v37, v54, v52, s23
    v_perm_b32 v38, v58, v56, s23
    v_perm_b32 v39, v62, v60, s23
    v_perm_b32 v40, v51, v49, s22
    v_perm_b32 v41, v55, v53, s22
    v_perm_b32 v42, v59, v57, s22
    v_perm_b32 v43, v63, v61, s22
    v_perm_b32 v44, v51, v49, s23
    v_perm_b32 v45, v55, v53, s23
    v_perm_b32 v46, v59, v57, s23
    v_perm_b32 v47, v63, v61, s23
    v_perm_b32 v48, v66, v64, s22
    v_perm_b32 v49, v70, v68, s22
    v_perm_b32 v50, v74, v72, s22
    v_perm_b32 v51, v78, v76, s22
    v_perm_b32 v52, v66, v64, s23
    v_perm_b32 v53, v70, v68, s23
    v_perm_b32 v54, v74, v72, s23
    v_perm_b32 v55, v78, v76, s23
    v_perm_b32 v56, v67, v65, s22
    v_perm_b32 v57, v71, v69, s22
    v_perm_b32 v58, v75, v73, s22
    v_perm_b32 v59, v79, v77, s22
    v_perm_b32 v60, v67, v65, s23
    v_perm_b32 v61, v71, v69, s23
    v_perm_b32 v62, v75, v73, s23
    v_perm_b32 v63, v79, v77, s23
    v_perm_b32 v64, v82, v80, s22
    v_perm_b32 v65, v86, v84, s22
    v_perm_b32 v66, v90, v88, s22
    v_perm_b32 v67, v94, v92, s22
    v_perm_b32 v68, v82, v80, s23
    v_perm_b32 v69, v86, v84, s23
    v_perm_b32 v70, v90, v88, s23
    v_perm_b32 v71, v94, v92, s23
    v_perm_b32 v72, v83, v81, s22
    v_perm_b32 v73, v87, v85, s22
    v_perm_b32 v74, v91, v89, s22
    v_perm_b32 v75, v95, v93, s22
    v_perm_b32 v76, v83, v81, s23
    v_perm_b32 v77, v87, v85, s23
    v_perm_b32 v78, v91, v89, s23
    v_perm_b32 v79, v95, v93, s23
    s_add_u32 s52, s30, 0x400000
    s_addc_u32 s53, s31, 0
    s_mov_b32 s54, 0xa2000
    s_mov_b32 s55, 0x00020000
    v_and_b32 v162, 7, v1
    v_mul_u32_u24 v162, 144, v162
    v_add_u32 v162, 0x17000, v162
    v_lshl_add_u32 v162, v10, 4, v162
    v_and_b32 v163, 15, v1
    v_mul_u32_u24 v163, 9, v163
    v_add_u32 v163, s20, v163
    v_mul_u32_u24 v163, 9216, v163
    v_lshl_add_u32 v163, v10, 5, v163
    s_lshl_b32 s62, s3, 7
    s_mov_b32 s60, 0x00ff00ff
    s_mov_b32 s61, 0x00ff00ff

    s_setprio 0
    s_cmp_eq_u32 s20, 9
    s_cbranch_scc1 KF_D9

    s_mov_b32 s81, 0
SY25:
    ds_read_b32 v167, v165 offset:52
    s_add_u32 s81, s81, 1
    s_cmp_gt_u32 s81, 0x400000
    s_cbranch_scc1 SY25_D
    s_waitcnt lgkmcnt(0)
    v_readfirstlane_b32 s80, v167
    s_cmp_ge_u32 s80, 1
    s_cbranch_scc1 SY25_D
    s_sleep 2
    s_branch SY25
SY25_D:
    ds_read_b64_tr_b16 v[96:97], v6 offset:0
    ds_read_b64_tr_b16 v[98:99], v6 offset:4608
    ds_read_b64_tr_b16 v[100:101], v6 offset:32
    ds_read_b64_tr_b16 v[102:103], v6 offset:4640
    ds_read_b64_tr_b16 v[104:105], v6 offset:64
    ds_read_b64_tr_b16 v[106:107], v6 offset:4672
    ds_read_b64_tr_b16 v[108:109], v6 offset:96
    ds_read_b64_tr_b16 v[110:111], v6 offset:4704
    ds_read_b64_tr_b16 v[112:113], v6 offset:36864
    ds_read_b64_tr_b16 v[114:115], v6 offset:41472
    ds_read_b64_tr_b16 v[116:117], v6 offset:36896
    ds_read_b64_tr_b16 v[118:119], v6 offset:41504
    ds_read_b64_tr_b16 v[120:121], v6 offset:36928
    ds_read_b64_tr_b16 v[122:123], v6 offset:41536
    ds_read_b64_tr_b16 v[124:125], v6 offset:36960
    ds_read_b64_tr_b16 v[126:127], v6 offset:41568
KF_D9:
    s_mov_b32 s18, 0x3210ffff
    s_mov_b32 s19, 0xff

    s_lshl_b32 s16, s20, 2
    s_lshr_b64 s[18:19], s[18:19], s16
    s_and_b32 s19, s18, 15
    s_cmp_ge_u32 s19, 4
    s_cbranch_scc1 KF_DX

    s_add_u32 s36, s30, 0x1410000
    s_addc_u32 s37, s31, 0
    s_mov_b32 s38, 0xb440
    s_mov_b32 s39, 0x00020000
    s_mov_b32 s81, 0
SY26:
    ds_read_b32 v167, v165 offset:104
    s_add_u32 s81, s81, 1
    s_cmp_gt_u32 s81, 0x400000
    s_cbranch_scc1 SY26_D
    s_waitcnt lgkmcnt(0)
    v_readfirstlane_b32 s80, v167
    s_cmp_ge_u32 s80, 1
    s_cbranch_scc1 SY26_D
    s_sleep 2
    s_branch SY26
SY26_D:
    s_mov_b32 s81, 0
SY27:
    ds_read_b32 v167, v165 offset:48
    s_add_u32 s81, s81, 1
    s_cmp_gt_u32 s81, 0x400000
    s_cbranch_scc1 SY27_D
    s_waitcnt lgkmcnt(0)
    v_readfirstlane_b32 s80, v167
    s_cmp_ge_u32 s80, 10
    s_cbranch_scc1 SY27_D
    s_sleep 2
    s_branch SY27
SY27_D:
    s_and_b32 s58, s2, 3
    s_mul_i32 s58, s58, 9216
    s_mul_i32 s59, s19, 2304
    s_add_u32 s58, s58, s59
    v_lshrrev_b32 v11, 5, v1
    v_lshlrev_b32 v8, 2, v1
    v_mul_u32_u24 v12, 1040, v11
    v_add_u32 v12, v12, v8
    v_lshl_add_u32 v8, v11, 10, v8
    s_mul_i32 s18, s19, 2336
    s_add_u32 s18, s18, 0x17500
    v_add_u32 v11, s18, v7
    v_add_u32 v12, s18, v12
    s_mov_b32 s63, 0

KF_SD_P:
    buffer_load_dwordx4 v[144:147], v7, s[36:39], s58 offen sc0 sc1
    buffer_load_dwordx4 v[148:151], v7, s[36:39], s58 offen offset:1152 sc0 sc1
    buffer_load_dword v160, v8, s[36:39], s58 offen offset:1024 sc0 sc1
    s_waitcnt vmcnt(0)
    v_max3_u32 v9, v144, v145, v146
    v_max3_u32 v9, v9, v147, v148
    v_max3_u32 v9, v9, v149, v150
    v_max3_u32 v9, v9, v151, v160
    v_cmp_eq_u32 vcc, -1, v9
    s_add_u32 s63, s63, 1
    s_cmp_gt_u32 s63, 200000
    s_cbranch_scc1 KF_SD_D0
    s_cbranch_vccz KF_SD_D0

    s_branch KF_SD_P
KF_SD_D0:
    ds_write_b128 v11, v[144:147]
    ds_write_b128 v11, v[148:151] offset:1168
    ds_write_b32 v12, v160 offset:1024
KF_DX:
    s_setprio 0
    s_waitcnt lgkmcnt(0)
    s_barrier

    ds_read_b128 v[80:83], v2 offset:0
    ds_read_b128 v[84:87], v2 offset:320
    ds_read_b128 v[88:91], v2 offset:640
    ds_read_b128 v[92:95], v2 offset:896
    v_cmp_gt_u32 vcc, 32, v1
    s_waitcnt lgkmcnt(3)
    v_mfma_f32_16x16x32_bf16 v[128:131], v[80:83], v[16:19], 0
    v_mfma_f32_16x16x32_bf16 v[132:135], v[80:83], v[20:23], 0
    v_mfma_f32_16x16x32_bf16 v[136:139], v[80:83], v[24:27], 0
    v_mfma_f32_16x16x32_bf16 v[140:143], v[80:83], v[28:31], 0
    s_waitcnt lgkmcnt(2)
    v_mfma_f32_16x16x32_bf16 v[128:131], v[84:87], v[32:35], v[128:131]
    v_mfma_f32_16x16x32_bf16 v[132:135], v[84:87], v[36:39], v[132:135]
    v_mfma_f32_16x16x32_bf16 v[136:139], v[84:87], v[40:43], v[136:139]
    v_mfma_f32_16x16x32_bf16 v[140:143], v[84:87], v[44:47], v[140:143]
    s_cmp_lt_u32 s20, 2
    s_cbranch_scc1 KF_DM1
    s_waitcnt lgkmcnt(1)
    v_mfma_f32_16x16x32_bf16 v[128:131], v[88:91], v[48:51], v[128:131]
    v_mfma_f32_16x16x32_bf16 v[132:135], v[88:91], v[52:55], v[132:135]
    v_mfma_f32_16x16x32_bf16 v[136:139], v[88:91], v[56:59], v[136:139]
    v_mfma_f32_16x16x32_bf16 v[140:143], v[88:91], v[60:63], v[140:143]
    s_waitcnt lgkmcnt(0)
    v_mfma_f32_16x16x32_bf16 v[128:131], v[92:95], v[64:67], v[128:131]
    v_mfma_f32_16x16x32_bf16 v[132:135], v[92:95], v[68:71], v[132:135]
    v_mfma_f32_16x16x32_bf16 v[136:139], v[92:95], v[72:75], v[136:139]
    v_mfma_f32_16x16x32_bf16 v[140:143], v[92:95], v[76:79], v[140:143]
KF_DM1:
    s_setprio 0
    s_nop 6
    s_and_saveexec_b64 s[18:19], vcc

    s_nop 3
    ds_write_b128 v3, v[128:131] offset:0
    s_nop 3
    ds_write_b128 v3, v[132:135] offset:512
    s_nop 3
    ds_write_b128 v3, v[136:139] offset:1024
    s_nop 3
    ds_write_b128 v3, v[140:143] offset:1536
    s_mov_b64 exec, s[18:19]
    v_lshlrev_b32 v2, 2, v0
    v_add_u32 v2, 0x12000, v2
    v_lshrrev_b32 v3, 3, v0
    v_and_b32 v4, 15, v3
    v_lshrrev_b32 v3, 4, v3
    v_lshl_add_u32 v3, v4, 2, v3
    v_and_b32 v4, 7, v0
    v_mul_u32_u24 v4, 144, v4
    v_lshl_add_u32 v4, v3, 1, v4
    v_add_u32 v4, 0x17000, v4
    s_mov_b32 s16, 0xbfb8aa3b
    s_waitcnt lgkmcnt(0)
    s_barrier

    s_cmp_ge_u32 s20, 8
    s_cbranch_scc1 KF_B5

    ds_read2st64_b32 v[16:17], v2 offset0:0 offset1:8
    ds_read2st64_b32 v[18:19], v2 offset0:16 offset1:24
    ds_read2st64_b32 v[20:21], v2 offset0:32 offset1:40
    ds_read2st64_b32 v[22:23], v2 offset0:48 offset1:56
    ds_read2st64_b32 v[24:25], v2 offset0:64 offset1:72
    s_waitcnt lgkmcnt(2)
    v_add_f32 v16, v16, v17
    v_add_f32 v18, v18, v19
    v_add_f32 v16, v16, v20
    v_add_f32 v16, v16, v18

    v_cvt_pk_bf16_f32 v16, v16, v16
    v_lshlrev_b32 v16, 16, v16
    v_mul_f32 v17, s16, v16
    v_exp_f32 v17, v17
    s_waitcnt lgkmcnt(0)
    v_add_f32 v21, v21, v22
    v_add_f32 v17, 1.0, v17
    v_rcp_f32 v17, v17
    v_add_f32 v23, v23, v24
    v_add_f32 v21, v21, v25
    v_add_f32 v19, v21, v23
    v_mul_f32 v17, v17, v16

    v_cvt_pk_bf16_f32 v19, v19, v19
    v_lshlrev_b32 v19, 16, v19
    v_cvt_pk_bf16_f32 v17, v17, v17
    v_lshlrev_b32 v17, 16, v17
    v_mul_f32 v17, v17, v19
    v_cvt_pk_bf16_f32 v17, v17, v17
    ds_write_b16 v4, v17
    s_waitcnt lgkmcnt(0)
KF_B5:

    s_cmp_eq_u32 s20, 9
    s_barrier
    s_cbranch_scc1 KF_FIN
    ds_read_b128 v[16:19], v162
    ds_read_b128 v[20:23], v162 offset:64
    s_waitcnt lgkmcnt(1)

    v_mfma_f32_16x16x32_bf16 v[128:131], v[96:99], v[16:19], 0
    v_mfma_f32_16x16x32_bf16 v[132:135], v[100:103], v[16:19], 0
    s_waitcnt lgkmcnt(0)
    v_mfma_f32_16x16x32_bf16 v[128:131], v[112:115], v[20:23], v[128:131]
    v_mfma_f32_16x16x32_bf16 v[132:135], v[116:119], v[20:23], v[132:135]
    v_mfma_f32_16x16x32_bf16 v[136:139], v[104:107], v[16:19], 0
    v_mfma_f32_16x16x32_bf16 v[140:143], v[108:111], v[16:19], 0
    v_mfma_f32_16x16x32_bf16 v[136:139], v[120:123], v[20:23], v[136:139]
    v_mfma_f32_16x16x32_bf16 v[140:143], v[124:127], v[20:23], v[140:143]
    v_cvt_pk_bf16_f32 v24, v128, v129
    v_cvt_pk_bf16_f32 v25, v130, v131
    v_cvt_pk_bf16_f32 v26, v132, v133
    v_cvt_pk_bf16_f32 v27, v134, v135
    v_or_b32 v24, 1, v24
    s_mov_b64 exec, s[60:61]
    buffer_store_dwordx4 v[24:27], v163, s[52:55], s62 offen sc0 sc1
    s_nop 4
    v_cvt_pk_bf16_f32 v28, v136, v137
    v_cvt_pk_bf16_f32 v29, v138, v139
    v_cvt_pk_bf16_f32 v30, v140, v141
    v_cvt_pk_bf16_f32 v31, v142, v143
    v_or_b32 v28, 1, v28
    buffer_store_dwordx4 v[28:31], v163, s[52:55], s62 offen offset:16 sc0 sc1
    s_branch KF_FIN
KF_H:
    s_cmp_lg_u32 s20, 8
    s_cbranch_scc1 KF_H3E
    s_sub_u32 s3, s2, 128

    s_lshr_b32 s16, s3, 1
    s_and_b32 s16, s16, 3
    s_mul_i32 s16, s16, 18
    s_lshr_b32 s17, s3, 3
    s_lshl_b32 s17, s17, 1
    s_and_b32 s3, s3, 1
    s_add_u32 s3, s3, s17

    v_mul_u32_u24 v8, 9216, v1
    s_mov_b32 s58, 0x510000
    s_mov_b32 s59, 0x00020000

    s_mov_b32 s81, 0
SY28:
    ds_read_b32 v167, v165 offset:32
    s_add_u32 s81, s81, 1
    s_cmp_gt_u32 s81, 0x400000
    s_cbranch_scc1 SY28_D
    s_waitcnt lgkmcnt(0)
    v_readfirstlane_b32 s80, v167
    s_cmp_ge_u32 s80, 4
    s_cbranch_scc1 SY28_D
    s_sleep 2
    s_branch SY28
SY28_D:
    s_waitcnt lgkmcnt(0)
    s_mul_i32 s21, s3, 43
    s_lshr_b32 s21, s21, 8
    s_mul_i32 s22, s21, 6
    s_sub_u32 s22, s3, s22

    s_bitcmp1_b32 s22, 0
    s_cselect_b32 s56, s26, s24
    s_cselect_b32 s57, s27, s25
    s_lshr_b32 s22, s22, 1
    s_lshr_b32 s23, s56, 7
    s_add_u32 s23, s23, s16
    s_sub_u32 s23, 3, s23
    s_and_b32 s23, s23, 7
    s_lshl_b32 s22, s22, 3
    s_add_u32 s23, s23, s22
    s_cmp_ge_u32 s23, 18
    s_cbranch_scc1 KF_H3_0
    s_cmp_ge_u32 s21, 9
    s_cbranch_scc1 KF_H3_0
    s_add_u32 s23, s23, s16
    s_lshl_b32 s23, s23, 7
    s_mul_i32 s21, s21, 589824
    s_add_u32 s23, s23, s21
    buffer_load_dword v9, v8, s[56:59], s23 offen
KF_H3_0:
    s_add_u32 s3, s3, 14

    s_mul_i32 s21, s3, 43
    s_lshr_b32 s21, s21, 8
    s_mul_i32 s22, s21, 6
    s_sub_u32 s22, s3, s22

    s_bitcmp1_b32 s22, 0
    s_cselect_b32 s56, s26, s24
    s_cselect_b32 s57, s27, s25
    s_lshr_b32 s22, s22, 1
    s_lshr_b32 s23, s56, 7
    s_add_u32 s23, s23, s16
    s_sub_u32 s23, 3, s23
    s_and_b32 s23, s23, 7
    s_lshl_b32 s22, s22, 3
    s_add_u32 s23, s23, s22
    s_cmp_ge_u32 s23, 18
    s_cbranch_scc1 KF_H3_1
    s_cmp_ge_u32 s21, 9
    s_cbranch_scc1 KF_H3_1
    s_add_u32 s23, s23, s16
    s_lshl_b32 s23, s23, 7
    s_mul_i32 s21, s21, 589824
    s_add_u32 s23, s23, s21
    buffer_load_dword v9, v8, s[56:59], s23 offen
KF_H3_1:
    s_add_u32 s3, s3, 14

    s_mul_i32 s21, s3, 43
    s_lshr_b32 s21, s21, 8
    s_mul_i32 s22, s21, 6
    s_sub_u32 s22, s3, s22

    s_bitcmp1_b32 s22, 0
    s_cselect_b32 s56, s26, s24
    s_cselect_b32 s57, s27, s25
    s_lshr_b32 s22, s22, 1
    s_lshr_b32 s23, s56, 7
    s_add_u32 s23, s23, s16
    s_sub_u32 s23, 3, s23
    s_and_b32 s23, s23, 7
    s_lshl_b32 s22, s22, 3
    s_add_u32 s23, s23, s22
    s_cmp_ge_u32 s23, 18
    s_cbranch_scc1 KF_H3_2
    s_cmp_ge_u32 s21, 9
    s_cbranch_scc1 KF_H3_2
    s_add_u32 s23, s23, s16
    s_lshl_b32 s23, s23, 7
    s_mul_i32 s21, s21, 589824
    s_add_u32 s23, s23, s21
    buffer_load_dword v9, v8, s[56:59], s23 offen
KF_H3_2:
    s_add_u32 s3, s3, 14

    s_mul_i32 s21, s3, 43
    s_lshr_b32 s21, s21, 8
    s_mul_i32 s22, s21, 6
    s_sub_u32 s22, s3, s22

    s_bitcmp1_b32 s22, 0
    s_cselect_b32 s56, s26, s24
    s_cselect_b32 s57, s27, s25
    s_lshr_b32 s22, s22, 1
    s_lshr_b32 s23, s56, 7
    s_add_u32 s23, s23, s16
    s_sub_u32 s23, 3, s23
    s_and_b32 s23, s23, 7
    s_lshl_b32 s22, s22, 3
    s_add_u32 s23, s23, s22
    s_cmp_ge_u32 s23, 18
    s_cbranch_scc1 KF_H3_3
    s_cmp_ge_u32 s21, 9
    s_cbranch_scc1 KF_H3_3
    s_add_u32 s23, s23, s16
    s_lshl_b32 s23, s23, 7
    s_mul_i32 s21, s21, 589824
    s_add_u32 s23, s23, s21
    buffer_load_dword v9, v8, s[56:59], s23 offen
KF_H3_3:
    s_add_u32 s3, s3, 14

KF_H3E:
    s_waitcnt vmcnt(0)
KF_FIN:
KF_END:
    s_endpgm

CODE_END:
.section .rodata,"a"
.p2align 6
.amdhsa_kernel kf_kernel
  .amdhsa_next_free_vgpr 168
  .amdhsa_next_free_sgpr 102
  .amdhsa_accum_offset 168
  .amdhsa_group_segment_fixed_size 0
  .amdhsa_kernarg_size 88
  .amdhsa_user_sgpr_count 2
  .amdhsa_user_sgpr_kernarg_segment_ptr 1
  .amdhsa_system_sgpr_workgroup_id_x 1
  .amdhsa_float_denorm_mode_32 3
.end_amdhsa_kernel
```
